```python
import torch

def _softmax(x, axis=-1):
    return torch.softmax(x, dim=axis)

def _gelu(x):
    return torch.nn.functional.gelu(x, approximate='tanh')

def _silu(x):
    return torch.nn.functional.silu(x)

def _sigmoid(x):
    return torch.sigmoid(x)

def _layernorm(x, axis=-1, eps=1e-05):
    m = x.mean(dim=axis, keepdim=True)
    v = x.var(dim=axis, keepdim=True, unbiased=False)
    return (x - m) / torch.sqrt(v + eps)

def _scatter_add(tgt, idx, src, axis=0):
    return tgt.clone().index_add_(axis, idx, src)

def _segment_sum(src, seg, n):
    out = torch.zeros((n,) + src.shape[1:], dtype=src.dtype)
    return out.index_add_(0, seg, src)

def _pad(x, pw):
    flat = tuple((v for pair in reversed(pw) for v in pair))
    return torch.nn.functional.pad(x, flat)
kernel_name = 'adaLN_cond__sliding_block_cached__glu_gated_geglu__decode'

def setup_inputs():

    _w = lambda a: (lambda t: t.to(torch.bfloat16) if t.is_floating_point() else t)(torch.as_tensor(a))

    def _A_setup():
        B, Sq, D = (1, 1, 512)
        Hq, Hkv, Sk, Dh = (32, 8, 65536, 128)
        assert Hq % Hkv == 0, (Hq, Hkv)
        return {'x': _w((lambda *s: torch.randn(*s, dtype=torch.bfloat16) * 0.05)(B, Sq, D)), 'k_cache': _w((lambda *s: torch.randn(*s, dtype=torch.bfloat16) * 0.8)(B, Hkv, Sk, Dh)), 'v_cache': _w((lambda *s: torch.randn(*s, dtype=torch.bfloat16) * 3.2)(B, Hkv, Sk, Dh)), 'wq': _w((lambda *s: torch.randn(*s, dtype=torch.bfloat16) * 0.8)(D, Hq * Dh) * D ** (-0.5)), 'wo': _w((lambda *s: torch.randn(*s, dtype=torch.bfloat16) * 3.2)(Hq * Dh, D) * (Hq * Dh) ** (-0.5))}
    _A_in = _A_setup()

    def _B_setup():
        B, S, Dm, Df = (1, 1, 512, 1792)
        return {'x': _w((lambda *s: torch.randn(*s, dtype=torch.bfloat16) * 0.05)(B, S, Dm)), 'w_gate': _w((lambda *s: torch.randn(*s, dtype=torch.bfloat16) * 3.2)(Dm, Df) * Dm ** (-0.5)), 'w_up': _w((lambda *s: torch.randn(*s, dtype=torch.bfloat16) * 3.2)(Dm, Df) * Dm ** (-0.5)), 'w_down': _w((lambda *s: torch.randn(*s, dtype=torch.bfloat16) * 3.2)(Df, Dm) * Df ** (-0.5))}
    _B_in = _B_setup()
    return {'A_x': _A_in['x'], 'A_k_cache': _A_in['k_cache'], 'A_v_cache': _A_in['v_cache'], 'A_wq': _A_in['wq'], 'A_wo': _A_in['wo'], 'B_x': _B_in['x'], 'B_w_gate': _B_in['w_gate'], 'B_w_up': _B_in['w_up'], 'B_w_down': _B_in['w_down'], 'c': _w((lambda *s: torch.randn(*s, dtype=torch.bfloat16) * 0.4)(1, 512) * 8.0), 'w_mod': _w((lambda *s: torch.randn(*s, dtype=torch.bfloat16) * 0.4)(512, 6 * 512) * 512 ** (-0.5) * 8.0)}

def reference(A_x, A_k_cache, A_v_cache, A_wq, A_wo, B_x, B_w_gate, B_w_up, B_w_down, c, w_mod):

    def _A_ref(x, k_cache, v_cache, wq, wo):
        B, Sq, D = x.shape
        Hq, Dh = (32, 128)
        Hkv, Sk = (k_cache.shape[1], k_cache.shape[2])
        W = min(4096, max(256, Sk // 4))
        rep = Hq // Hkv
        q = (lambda x, *d: x.permute(*d))((x @ wq).reshape(B, Sq, Hq, Dh), 0, 2, 1, 3)
        k = (lambda x, n, axis: torch.repeat_interleave(x, n, dim=axis))(k_cache[:, :, Sk - W:, :], rep, axis=1)
        v = (lambda x, n, axis: torch.repeat_interleave(x, n, dim=axis))(v_cache[:, :, Sk - W:, :], rep, axis=1)
        scores = torch.einsum('bhqd,bhkd->bhqk', q, k) * Dh ** (-0.5)
        p = _softmax(scores, axis=-1)
        o = torch.einsum('bhqk,bhkd->bhqd', p, v)
        return (lambda x, *d: x.permute(*d))(o, 0, 2, 1, 3).reshape(B, Sq, Hq * Dh) @ wo

    def _B_ref(x, w_gate, w_up, w_down):
        g = torch.einsum('bsd,df->bsf', x, w_gate)
        u = torch.einsum('bsd,df->bsf', x, w_up)
        h = _gelu(g) * u
        return torch.einsum('bsf,fd->bsd', h, w_down)
    x = A_x
    mod = (_silu(c) @ w_mod).reshape(c.shape[0], 6, 1, -1)
    sa, ca, ga, sb, cb, gb = (mod[:, 0].clone(), mod[:, 1].clone(), mod[:, 2].clone(), mod[:, 3].clone(), mod[:, 4].clone(), mod[:, 5].clone())
    h = _layernorm(x, axis=-1) * (1 + ca) + sa
    x = x + ga * _A_ref(h, A_k_cache, A_v_cache, A_wq, A_wo)
    h = _layernorm(x, axis=-1) * (1 + cb) + sb
    x = x + gb * _B_ref(h, B_w_gate, B_w_up, B_w_down)
    return x
```

```asm
; @launch grid=(256,1,1) block=(512,1,1) lds=98304
.amdgcn_target "amdgcn-amd-amdhsa--gfx950"
.text
.globl adaLN_cond__sliding_block_cached__glu_gated_geglu__decode_kernel
.p2align 8
.type adaLN_cond__sliding_block_cached__glu_gated_geglu__decode_kernel,@function
adaLN_cond__sliding_block_cached__glu_gated_geglu__decode_kernel:
    s_cmp_ge_u32 s2, 256
    s_cbranch_scc1 L_end0
    s_load_dwordx16 s[16:31], s[0:1], 0
    s_load_dwordx8 s[32:39], s[0:1], 64
    s_load_dwordx4 s[40:43], s[0:1], 96
    s_getpc_b64 s[12:13]
L_pc:
    v_lshrrev_b32 v4, 6, v0
    v_and_b32 v1, 63, v0
    v_readfirstlane_b32 s3, v4
    v_lshrrev_b32 v2, 4, v1
    v_and_b32 v3, 15, v1
    s_and_b32 s4, s2, 7
    s_lshr_b32 s5, s2, 3
    s_lshl_b32 s48, s4, 16
    s_add_u32 s48, s48, 524288
    v_lshlrev_b32 v12, 4, v1
    s_cmp_lg_u32 s3, 7
    s_cbranch_scc1 L_nopf
    s_lshl_b32 s6, s5, 10
    s_cmp_ge_u32 s6, L_code_end-L_pc-1024
    s_cbranch_scc1 L_nopf
    v_add_u32 v11, s6, v12
    global_load_dwordx4 v[84:87], v11, s[12:13] offset:1024
L_nopf:
    v_lshrrev_b32 v7, 3, v3
    v_and_b32 v8, 7, v3
    v_mov_b32 v6, 0
    s_mov_b32 s46, 8388608
    s_mov_b32 s47, 0x00020000
    s_cmp_lt_u32 s5, 16
    s_cbranch_scc1 L_earlyW
    s_sub_u32 s8, s5, 16
    s_lshl_b32 s6, s4, 24
    s_lshl_b32 s7, s3, 4
    s_add_u32 s7, s7, s8
    s_lshl_b32 s7, s7, 13
    s_add_u32 s6, s6, s7
    s_add_u32 s6, s6, 15732736
    v_add_u32 v11, s6, v12
    v_lshlrev_b32 v12, 10, v2
    v_lshl_add_u32 v12, v3, 4, v12
    v_add_u32 v12, s6, v12
    s_waitcnt lgkmcnt(0)
    s_mov_b32 s44, s42
    s_mov_b32 s45, s43
    buffer_load_dword v4, v6, s[44:47], 0 offen offset:0 sc1
    global_load_dwordx4 v[16:19], v11, s[18:19] offset:-4096 nt
    global_load_dwordx4 v[20:23], v11, s[18:19] offset:-3072 nt
    global_load_dwordx4 v[24:27], v11, s[18:19] offset:-2048 nt
    global_load_dwordx4 v[28:31], v11, s[18:19] offset:-1024 nt
    global_load_dwordx4 v[32:35], v11, s[18:19] offset:0 nt
    global_load_dwordx4 v[36:39], v11, s[18:19] offset:1024 nt
    global_load_dwordx4 v[40:43], v11, s[18:19] offset:2048 nt
    global_load_dwordx4 v[44:47], v11, s[18:19] offset:3072 nt
    s_branch L_roleA
L_earlyW:
    v_lshl_add_u32 v9, v7, 2, v2
    v_and_b32 v10, 1, v3
    v_lshl_add_u32 v10, v10, 2, v2
    s_cmp_ge_u32 s5, 8
    s_cbranch_scc1 L_earlyWF
    s_and_b32 s6, s5, 6
    s_and_b32 s7, s3, 1
    s_add_u32 s9, s6, s7
    s_lshl_b32 s6, s9, 19
    s_lshl_b32 s7, s4, 10
    s_add_u32 s6, s6, s7
    s_and_b32 s7, s5, 1
    s_lshl_b32 s7, s7, 2
    s_lshr_b32 s8, s3, 1
    s_add_u32 s8, s8, s7
    s_lshl_b32 s7, s8, 7
    s_add_u32 s6, s6, s7
    s_waitcnt lgkmcnt(0)
    s_mov_b32 s44, s42
    s_mov_b32 s45, s43
    s_lshl_b32 s7, s5, 13
    s_lshl_b32 s14, s3, 10
    s_add_u32 s7, s7, s14
    s_add_u32 s14, s7, s48
    s_and_b32 s7, s7, 0x7fff
    v_lshlrev_b32 v11, 7, v8
    s_mov_b64 exec, 0xff
    buffer_load_dword v80, v11, s[44:47], s14 offen
    buffer_load_dword v81, v11, s[44:47], s7 offen
    s_mov_b64 exec, -1
    s_movk_i32 s7, 0x2000
    s_mov_b64 s[10:11], s[22:23]
    s_branch L_earlyTile
L_earlyWF:
    s_sub_u32 s8, s5, 8
    s_cmp_ge_u32 s3, 2
    s_cbranch_scc1 L_earlyNone
    s_lshl_b32 s6, s4, 7
    s_lshl_b32 s7, s3, 10
    s_add_u32 s6, s6, s7
    s_lshl_b32 s7, s8, 7
    v_lshlrev_b32 v11, 4, v10
    v_add_u32 v11, s7, v11
    s_mul_i32 s7, s8, 393216
    s_add_u32 s6, s6, s7
    s_movk_i32 s7, 6144
    s_waitcnt lgkmcnt(0)
    global_load_dwordx4 v[80:83], v11, s[34:35]
    s_mov_b64 s[10:11], s[36:37]
L_earlyTile:
    s_lshl_b32 s14, s7, 3
    v_mul_lo_u32 v11, v9, s14
    v_lshl_add_u32 v11, v8, 4, v11
    v_add_u32 v11, s6, v11
    global_load_dwordx4 v[16:19], v11, s[10:11] nt
    v_add_u32 v11, s7, v11
    global_load_dwordx4 v[20:23], v11, s[10:11] nt
    v_add_u32 v11, s7, v11
    global_load_dwordx4 v[24:27], v11, s[10:11] nt
    v_add_u32 v11, s7, v11
    global_load_dwordx4 v[28:31], v11, s[10:11] nt
    v_add_u32 v11, s7, v11
    global_load_dwordx4 v[32:35], v11, s[10:11] nt
    v_add_u32 v11, s7, v11
    global_load_dwordx4 v[36:39], v11, s[10:11] nt
    v_add_u32 v11, s7, v11
    global_load_dwordx4 v[40:43], v11, s[10:11] nt
    v_add_u32 v11, s7, v11
    global_load_dwordx4 v[44:47], v11, s[10:11] nt
L_earlyNone:
    s_waitcnt lgkmcnt(0)
    s_mov_b32 s44, s42
    s_mov_b32 s45, s43
    buffer_load_dword v4, v6, s[44:47], 0 offen offset:0 sc1
    s_cmp_lt_u32 s5, 8
    s_cbranch_scc1 L_roleWQ
L_roleWF:
    s_mov_b32 s49, 1048576
    s_mov_b32 s50, 0x05040100
    s_mov_b32 s51, 0x07060302
    s_mov_b32 s52, 0xff00ff00
    s_mov_b32 s53, 0xff00ff00
    s_mov_b32 s54, 0x0c0c0400
    s_mov_b32 s55, 0x04000c0c
    s_mov_b32 s56, 0xffffff00
    s_mov_b32 s57, 0
    s_mov_b32 s63, 255
    s_mov_b32 s84, 0x07060500
    s_mov_b32 s85, 0x07060501
    s_mov_b32 s86, 0x07060502
    s_mov_b32 s87, 0x07060503
    s_cmp_lg_u32 s3, 2
    s_cbranch_scc1 L_wf_notouch
    s_cmp_lg_u32 s8, 0
    s_cbranch_scc1 L_wf_notouch
    s_lshl_b32 s6, s4, 7
    v_lshl_add_u32 v11, v3, 2, v2
    v_lshlrev_b32 v11, 1, v11
    v_add_u32 v11, s6, v11
    global_load_dwordx4 v[80:83], v12, s[16:17]
    global_load_ushort v85, v11, s[16:17]
L_wf_notouch:
    s_lshl_b32 s6, s3, 9
    v_lshlrev_b32 v88, 8, v7
    v_lshl_add_u32 v88, v8, 5, v88
    v_add_u32 v88, s6, v88
    v_lshlrev_b32 v89, 10, v2
    v_lshl_add_u32 v89, v3, 4, v89
    v_lshlrev_b32 v90, 2, v2
    v_lshl_add_u32 v90, v3, 4, v90
    s_lshl_b32 s6, s3, 7
    v_lshrrev_b32 v91, 1, v90
    v_add_u32 v91, s6, v91
    v_lshlrev_b32 v92, 4, v10
    v_add_u32 v92, s6, v92
    global_load_dwordx4 v[196:199], v92, s[34:35]
    s_lshl_b32 s6, s4, 19
    s_lshl_b32 s7, s3, 16
    s_add_u32 s6, s6, s7
    s_lshl_b32 s7, s8, 7
    s_add_u32 s6, s6, s7
    v_lshlrev_b32 v205, 15, v7
    v_lshl_add_u32 v205, v2, 11, v205
    v_lshl_add_u32 v205, v8, 4, v205
    v_add_u32 v205, s6, v205
    s_and_b32 s6, s8, 3
    s_lshl_b32 s9, s4, 2
    s_add_u32 s9, s9, s6
    s_mul_i32 s10, s3, 393216
    s_lshl_b32 s11, s9, 7
    s_add_u32 s10, s10, s11
    s_add_u32 s10, s10, 2048
    v_mul_u32_u24 v206, 49152, v9
    v_lshl_add_u32 v206, v8, 4, v206
    v_add_u32 v206, s10, v206
    s_cmp_ge_u32 s3, 2
    s_cbranch_scc1 L_s1_idle
    s_lshl_b32 s6, s8, 1
    s_add_u32 s6, s6, s3
    s_lshl_b32 s6, s6, 8
    s_add_u32 s6, s6, s48
    s_add_u32 s6, s6, 49152
    v_lshlrev_b32 v200, 5, v8
    v_and_b32 v13, 1, v2
    v_lshl_add_u32 v200, v13, 4, v200
    v_lshrrev_b32 v13, 1, v2
    v_lshl_add_u32 v200, v13, 12, v200
    v_add_u32 v200, s6, v200
    s_waitcnt vmcnt(10)
    v_lshlrev_b32 v164, 16, v80
    v_and_b32 v165, 0xffff0000, v80
    v_lshlrev_b32 v166, 16, v81
    v_and_b32 v167, 0xffff0000, v81
    v_lshlrev_b32 v168, 16, v82
    v_and_b32 v169, 0xffff0000, v82
    v_lshlrev_b32 v170, 16, v83
    v_and_b32 v171, 0xffff0000, v83
    v_mul_f32 v172, 0xbfb8aa3b, v164
    v_mul_f32 v173, 0xbfb8aa3b, v165
    v_mul_f32 v174, 0xbfb8aa3b, v166
    v_mul_f32 v175, 0xbfb8aa3b, v167
    v_mul_f32 v176, 0xbfb8aa3b, v168
    v_mul_f32 v177, 0xbfb8aa3b, v169
    v_mul_f32 v178, 0xbfb8aa3b, v170
    v_mul_f32 v179, 0xbfb8aa3b, v171
    v_exp_f32 v172, v172
    v_exp_f32 v173, v173
    v_exp_f32 v174, v174
    v_exp_f32 v175, v175
    v_exp_f32 v176, v176
    v_exp_f32 v177, v177
    v_exp_f32 v178, v178
    v_exp_f32 v179, v179
    v_add_f32 v172, 1.0, v172
    v_add_f32 v173, 1.0, v173
    v_add_f32 v174, 1.0, v174
    v_add_f32 v175, 1.0, v175
    v_add_f32 v176, 1.0, v176
    v_add_f32 v177, 1.0, v177
    v_add_f32 v178, 1.0, v178
    v_add_f32 v179, 1.0, v179
    v_rcp_f32 v172, v172
    v_rcp_f32 v173, v173
    v_rcp_f32 v174, v174
    v_rcp_f32 v175, v175
    v_rcp_f32 v176, v176
    v_rcp_f32 v177, v177
    v_rcp_f32 v178, v178
    v_rcp_f32 v179, v179
    v_mul_f32 v164, v164, v172
    v_mul_f32 v165, v165, v173
    v_mul_f32 v166, v166, v174
    v_mul_f32 v167, v167, v175
    v_mul_f32 v168, v168, v176
    v_mul_f32 v169, v169, v177
    v_mul_f32 v170, v170, v178
    v_mul_f32 v171, v171, v179
    v_cvt_pk_bf16_f32 v160, v164, v165
    v_cvt_pk_bf16_f32 v161, v166, v167
    v_cvt_pk_bf16_f32 v162, v168, v169
    v_cvt_pk_bf16_f32 v163, v170, v171
    s_waitcnt vmcnt(8)
    v_perm_b32 v48, v20, v16, s50
    v_perm_b32 v52, v20, v16, s51
    v_perm_b32 v56, v21, v17, s50
    v_perm_b32 v60, v21, v17, s51
    v_perm_b32 v64, v22, v18, s50
    v_perm_b32 v68, v22, v18, s51
    v_perm_b32 v72, v23, v19, s50
    v_perm_b32 v76, v23, v19, s51
    s_waitcnt vmcnt(6)
    v_perm_b32 v49, v28, v24, s50
    v_perm_b32 v53, v28, v24, s51
    v_perm_b32 v57, v29, v25, s50
    v_perm_b32 v61, v29, v25, s51
    v_perm_b32 v65, v30, v26, s50
    v_perm_b32 v69, v30, v26, s51
    v_perm_b32 v73, v31, v27, s50
    v_perm_b32 v77, v31, v27, s51
    s_waitcnt vmcnt(4)
    v_perm_b32 v50, v36, v32, s50
    v_perm_b32 v54, v36, v32, s51
    v_perm_b32 v58, v37, v33, s50
    v_perm_b32 v62, v37, v33, s51
    v_perm_b32 v66, v38, v34, s50
    v_perm_b32 v70, v38, v34, s51
    v_perm_b32 v74, v39, v35, s50
    v_perm_b32 v78, v39, v35, s51
    s_waitcnt vmcnt(2)
    v_perm_b32 v51, v44, v40, s50
    v_perm_b32 v55, v44, v40, s51
    v_perm_b32 v59, v45, v41, s50
    v_perm_b32 v63, v45, v41, s51
    v_perm_b32 v67, v46, v42, s50
    v_perm_b32 v71, v46, v42, s51
    v_perm_b32 v75, v47, v43, s50
    v_perm_b32 v79, v47, v43, s51
    v_mfma_f32_16x16x32_bf16 v[128:131], v[160:163], v[48:51], 0
    v_mfma_f32_16x16x32_bf16 v[132:135], v[160:163], v[52:55], 0
    v_mfma_f32_16x16x32_bf16 v[136:139], v[160:163], v[56:59], 0
    v_mfma_f32_16x16x32_bf16 v[140:143], v[160:163], v[60:63], 0
    v_mfma_f32_16x16x32_bf16 v[144:147], v[160:163], v[64:67], 0
    v_mfma_f32_16x16x32_bf16 v[148:151], v[160:163], v[68:71], 0
    v_mfma_f32_16x16x32_bf16 v[152:155], v[160:163], v[72:75], 0
    v_mfma_f32_16x16x32_bf16 v[156:159], v[160:163], v[76:79], 0
    s_waitcnt vmcnt(0)
    v_and_b32 v5, 0x7f7f7f7f, v4
    v_add_u32 v5, 0x4f2b1d35, v5
    v_and_b32 v4, 0x80808080, v4
    v_xor_b32 v4, v4, v5
    v_lshlrev_b32 v5, 3, v2
    v_lshrrev_b32 v5, v5, v4
    v_and_b32 v5, 0xff, v5
    v_cndmask_b32 v172, v128, v129, s[52:53]
    v_cndmask_b32 v173, v132, v133, s[52:53]
    v_cndmask_b32 v174, v136, v137, s[52:53]
    v_cndmask_b32 v175, v140, v141, s[52:53]
    v_cndmask_b32 v176, v144, v145, s[52:53]
    v_cndmask_b32 v177, v148, v149, s[52:53]
    v_cndmask_b32 v178, v152, v153, s[52:53]
    v_cndmask_b32 v179, v156, v157, s[52:53]
    v_add_f32_dpp v172, v172, v172 row_ror:8 row_mask:0xf bank_mask:0xf
    v_add_f32_dpp v173, v173, v173 row_ror:8 row_mask:0xf bank_mask:0xf
    v_add_f32_dpp v174, v174, v174 row_ror:8 row_mask:0xf bank_mask:0xf
    v_add_f32_dpp v175, v175, v175 row_ror:8 row_mask:0xf bank_mask:0xf
    v_add_f32_dpp v176, v176, v176 row_ror:8 row_mask:0xf bank_mask:0xf
    v_add_f32_dpp v177, v177, v177 row_ror:8 row_mask:0xf bank_mask:0xf
    v_add_f32_dpp v178, v178, v178 row_ror:8 row_mask:0xf bank_mask:0xf
    v_add_f32_dpp v179, v179, v179 row_ror:8 row_mask:0xf bank_mask:0xf
    s_mov_b32 vcc_lo, 0xffff0000
    s_mov_b32 vcc_hi, 0xffff0000
    v_cndmask_b32 v172, v172, v176, vcc
    v_cndmask_b32 v173, v173, v177, vcc
    v_cndmask_b32 v174, v174, v178, vcc
    v_cndmask_b32 v175, v175, v179, vcc
    v_and_b32 v180, s56, v172
    v_sub_f32 v184, v172, v180
    v_and_b32 v181, s56, v173
    v_sub_f32 v185, v173, v181
    v_and_b32 v182, s56, v174
    v_sub_f32 v186, v174, v182
    v_and_b32 v183, s56, v175
    v_sub_f32 v187, v175, v183
    s_mov_b32 vcc_lo, 0
    s_mov_b32 vcc_hi, -1
    v_cndmask_b32 v180, v180, v184, vcc
    v_cndmask_b32 v181, v181, v185, vcc
    v_cndmask_b32 v182, v182, v186, vcc
    v_cndmask_b32 v183, v183, v187, vcc
    v_perm_b32 v180, v180, v4, s84
    v_perm_b32 v181, v181, v4, s85
    v_perm_b32 v182, v182, v4, s86
    v_perm_b32 v183, v183, v4, s87
    s_mov_b32 exec_lo, 0x00ff00ff
    s_mov_b32 exec_hi, 0x00ff00ff
    buffer_store_dwordx4 v[180:183], v200, s[44:47], 0 offen
    buffer_store_dwordx4 v[180:183], v200, s[44:47], s49 offen sc1
    s_mov_b64 exec, -1
    s_branch L_s1_done
L_s1_idle:
    s_cmp_lg_u32 s3, 2
    s_cbranch_scc1 L_s1_nocomb
    s_cmp_lg_u32 s8, 0
    s_cbranch_scc1 L_s1_nocomb
    v_lshlrev_b32 v200, 9, v2
    v_lshl_add_u32 v200, v3, 4, v200
    s_add_u32 s7, s48, 49152
    v_add_u32 v200, s7, v200
    v_add_u32 v201, 4096, v200
    s_lshl_b32 s6, s4, 8
    s_add_u32 s7, s6, 4096
    v_add_u32 v11, s7, v90
    s_waitcnt vmcnt(1)
    v_and_b32 v5, 0x7f7f7f7f, v4
    v_add_u32 v5, 0x4f2b1d35, v5
    v_and_b32 v4, 0x80808080, v4
    v_xor_b32 v4, v4, v5
    v_lshlrev_b32 v5, 3, v2
    v_lshrrev_b32 v5, v5, v4
    v_and_b32 v5, 0xff, v5
    v_lshlrev_b32 v164, 16, v80
    v_and_b32 v165, 0xffff0000, v80
    v_lshlrev_b32 v166, 16, v81
    v_and_b32 v167, 0xffff0000, v81
    v_lshlrev_b32 v168, 16, v82
    v_and_b32 v169, 0xffff0000, v82
    v_lshlrev_b32 v170, 16, v83
    v_and_b32 v171, 0xffff0000, v83
    v_add_f32 v13, v164, v165
    v_add_f32 v13, v13, v166
    v_add_f32 v13, v13, v167
    v_add_f32 v13, v13, v168
    v_add_f32 v13, v13, v169
    v_add_f32 v13, v13, v170
    v_add_f32 v13, v13, v171
    s_nop 1
    v_add_f32_dpp v13, v13, v13 row_ror:8 row_mask:0xf bank_mask:0xf
    s_nop 1
    v_add_f32_dpp v13, v13, v13 row_ror:4 row_mask:0xf bank_mask:0xf
    s_nop 1
    v_add_f32_dpp v13, v13, v13 row_ror:2 row_mask:0xf bank_mask:0xf
    s_nop 1
    v_add_f32_dpp v13, v13, v13 row_ror:1 row_mask:0xf bank_mask:0xf
    v_mov_b32 v15, v13
    s_nop 1
    v_permlane16_swap_b32 v13, v15
    v_add_f32 v13, v13, v15
    v_mov_b32 v15, v13
    s_nop 1
    v_permlane32_swap_b32 v13, v15
    v_add_f32 v13, v13, v15
    v_mul_f32 v207, 0x3b000000, v13
    v_sub_f32 v164, v164, v207
    v_sub_f32 v165, v165, v207
    v_sub_f32 v166, v166, v207
    v_sub_f32 v167, v167, v207
    v_sub_f32 v168, v168, v207
    v_sub_f32 v169, v169, v207
    v_sub_f32 v170, v170, v207
    v_sub_f32 v171, v171, v207
    v_mul_f32 v13, v164, v164
    v_fmac_f32 v13, v165, v165
    v_fmac_f32 v13, v166, v166
    v_fmac_f32 v13, v167, v167
    v_fmac_f32 v13, v168, v168
    v_fmac_f32 v13, v169, v169
    v_fmac_f32 v13, v170, v170
    v_fmac_f32 v13, v171, v171
    s_nop 1
    v_add_f32_dpp v13, v13, v13 row_ror:8 row_mask:0xf bank_mask:0xf
    s_nop 1
    v_add_f32_dpp v13, v13, v13 row_ror:4 row_mask:0xf bank_mask:0xf
    s_nop 1
    v_add_f32_dpp v13, v13, v13 row_ror:2 row_mask:0xf bank_mask:0xf
    s_nop 1
    v_add_f32_dpp v13, v13, v13 row_ror:1 row_mask:0xf bank_mask:0xf
    v_mov_b32 v15, v13
    s_nop 1
    v_permlane16_swap_b32 v13, v15
    v_add_f32 v13, v13, v15
    v_mov_b32 v15, v13
    s_nop 1
    v_permlane32_swap_b32 v13, v15
    v_add_f32 v13, v13, v15
    v_mul_f32 v13, 0x3b000000, v13
    v_cvt_pk_bf16_f32 v207, v207, v207
    v_and_b32 v207, 0xffff0000, v207
    v_cvt_pk_bf16_f32 v13, v13, v13
    v_and_b32 v13, 0xffff0000, v13
    v_add_f32 v13, 0x3727c5ac, v13
    v_cvt_pk_bf16_f32 v13, v13, v13
    v_and_b32 v13, 0xffff0000, v13
    v_sqrt_f32 v13, v13
    s_nop 0
    v_cvt_pk_bf16_f32 v13, v13, v13
    v_and_b32 v13, 0xffff0000, v13
    v_rcp_f32 v208, v13
    v_lshlrev_b32 v204, 16, v85
    v_sub_f32 v204, v204, v207
    v_cvt_pk_bf16_f32 v204, v204, v204
    v_and_b32 v204, 0xffff0000, v204
    v_mul_f32 v204, v204, v208
    v_cvt_pk_bf16_f32 v204, v204, v204
    v_and_b32 v204, 0xffff0000, v204
    s_nop 2
    s_branch L_poll_1_p
L_poll_1_s:
    s_mov_b32 s63, 3
    s_waitcnt vmcnt(0)
    buffer_load_dwordx4 v[96:99], v200, s[44:47], s49 offen offset:0 sc1
    buffer_load_dwordx4 v[100:103], v200, s[44:47], s49 offen offset:256 sc1
    buffer_load_dwordx4 v[104:107], v200, s[44:47], s49 offen offset:2048 sc1
    buffer_load_dwordx4 v[108:111], v200, s[44:47], s49 offen offset:2304 sc1
    buffer_load_dwordx4 v[112:115], v201, s[44:47], s49 offen offset:0 sc1
    buffer_load_dwordx4 v[116:119], v201, s[44:47], s49 offen offset:256 sc1
    buffer_load_dwordx4 v[120:123], v201, s[44:47], s49 offen offset:2048 sc1
    buffer_load_dwordx4 v[124:127], v201, s[44:47], s49 offen offset:2304 sc1
    s_waitcnt vmcnt(7)
    v_perm_b32 v13, v97, v96, s54
    v_perm_b32 v14, v99, v98, s55
    v_bitop3_b32 v15, v13, v14, v4 bitop3:0x56
    s_waitcnt vmcnt(6)
    v_perm_b32 v13, v101, v100, s54
    v_perm_b32 v14, v103, v102, s55
    v_bitop3_b32 v13, v13, v14, v4 bitop3:0x56
    v_or_b32 v15, v15, v13
    s_waitcnt vmcnt(5)
    v_perm_b32 v13, v105, v104, s54
    v_perm_b32 v14, v107, v106, s55
    v_bitop3_b32 v13, v13, v14, v4 bitop3:0x56
    v_or_b32 v15, v15, v13
    s_waitcnt vmcnt(4)
    v_perm_b32 v13, v109, v108, s54
    v_perm_b32 v14, v111, v110, s55
    v_bitop3_b32 v13, v13, v14, v4 bitop3:0x56
    v_or_b32 v15, v15, v13
    s_waitcnt vmcnt(3)
    v_perm_b32 v13, v113, v112, s54
    v_perm_b32 v14, v115, v114, s55
    v_bitop3_b32 v13, v13, v14, v4 bitop3:0x56
    v_or_b32 v15, v15, v13
    s_waitcnt vmcnt(2)
    v_perm_b32 v13, v117, v116, s54
    v_perm_b32 v14, v119, v118, s55
    v_bitop3_b32 v13, v13, v14, v4 bitop3:0x56
    v_or_b32 v15, v15, v13
    s_waitcnt vmcnt(1)
    v_perm_b32 v13, v121, v120, s54
    v_perm_b32 v14, v123, v122, s55
    v_bitop3_b32 v13, v13, v14, v4 bitop3:0x56
    v_or_b32 v15, v15, v13
    s_waitcnt vmcnt(0)
    v_perm_b32 v13, v125, v124, s54
    v_perm_b32 v14, v127, v126, s55
    v_bitop3_b32 v13, v13, v14, v4 bitop3:0x56
    v_or_b32 v15, v15, v13
    v_cmp_ne_u32 vcc, 0, v15
    s_mov_b64 exec, vcc
    s_cbranch_vccz L_poll_1_d
L_poll_1_p:
L_poll_1:
    buffer_load_dwordx4 v[96:99], v200, s[44:47], 0 offen offset:0 sc1
    buffer_load_dwordx4 v[100:103], v200, s[44:47], 0 offen offset:256 sc1
    buffer_load_dwordx4 v[104:107], v200, s[44:47], 0 offen offset:2048 sc1
    buffer_load_dwordx4 v[108:111], v200, s[44:47], 0 offen offset:2304 sc1
    buffer_load_dwordx4 v[112:115], v201, s[44:47], 0 offen offset:0 sc1
    buffer_load_dwordx4 v[116:119], v201, s[44:47], 0 offen offset:256 sc1
    buffer_load_dwordx4 v[120:123], v201, s[44:47], 0 offen offset:2048 sc1
    buffer_load_dwordx4 v[124:127], v201, s[44:47], 0 offen offset:2304 sc1
    s_add_u32 s57, s57, 1
    s_cmp_gt_u32 s57, 200000
    s_cbranch_scc1 L_end
    s_and_b32 s59, s57, s63
    s_cbranch_scc0 L_poll_1_s
    s_waitcnt vmcnt(7)
    v_perm_b32 v13, v97, v96, s54
    v_perm_b32 v14, v99, v98, s55
    v_bitop3_b32 v15, v13, v14, v4 bitop3:0x56
    s_waitcnt vmcnt(6)
    v_perm_b32 v13, v101, v100, s54
    v_perm_b32 v14, v103, v102, s55
    v_bitop3_b32 v13, v13, v14, v4 bitop3:0x56
    v_or_b32 v15, v15, v13
    s_waitcnt vmcnt(5)
    v_perm_b32 v13, v105, v104, s54
    v_perm_b32 v14, v107, v106, s55
    v_bitop3_b32 v13, v13, v14, v4 bitop3:0x56
    v_or_b32 v15, v15, v13
    s_waitcnt vmcnt(4)
    v_perm_b32 v13, v109, v108, s54
    v_perm_b32 v14, v111, v110, s55
    v_bitop3_b32 v13, v13, v14, v4 bitop3:0x56
    v_or_b32 v15, v15, v13
    s_waitcnt vmcnt(3)
    v_perm_b32 v13, v113, v112, s54
    v_perm_b32 v14, v115, v114, s55
    v_bitop3_b32 v13, v13, v14, v4 bitop3:0x56
    v_or_b32 v15, v15, v13
    s_waitcnt vmcnt(2)
    v_perm_b32 v13, v117, v116, s54
    v_perm_b32 v14, v119, v118, s55
    v_bitop3_b32 v13, v13, v14, v4 bitop3:0x56
    v_or_b32 v15, v15, v13
    s_waitcnt vmcnt(1)
    v_perm_b32 v13, v121, v120, s54
    v_perm_b32 v14, v123, v122, s55
    v_bitop3_b32 v13, v13, v14, v4 bitop3:0x56
    v_or_b32 v15, v15, v13
    s_waitcnt vmcnt(0)
    v_perm_b32 v13, v125, v124, s54
    v_perm_b32 v14, v127, v126, s55
    v_bitop3_b32 v13, v13, v14, v4 bitop3:0x56
    v_or_b32 v15, v15, v13
    v_cmp_ne_u32 vcc, 0, v15
    s_mov_b64 exec, vcc
    s_cbranch_vccnz L_poll_1
L_poll_1_d:
    s_mov_b64 exec, -1
    v_and_b32 v96, s56, v96
    v_and_b32 v97, s56, v97
    v_and_b32 v98, s56, v98
    v_and_b32 v99, s56, v99
    v_and_b32 v100, s56, v100
    v_and_b32 v101, s56, v101
    v_and_b32 v102, s56, v102
    v_and_b32 v103, s56, v103
    v_and_b32 v104, s56, v104
    v_and_b32 v105, s56, v105
    v_and_b32 v106, s56, v106
    v_and_b32 v107, s56, v107
    v_and_b32 v108, s56, v108
    v_and_b32 v109, s56, v109
    v_and_b32 v110, s56, v110
    v_and_b32 v111, s56, v111
    v_and_b32 v112, s56, v112
    v_and_b32 v113, s56, v113
    v_and_b32 v114, s56, v114
    v_and_b32 v115, s56, v115
    v_and_b32 v116, s56, v116
    v_and_b32 v117, s56, v117
    v_and_b32 v118, s56, v118
    v_and_b32 v119, s56, v119
    v_and_b32 v120, s56, v120
    v_and_b32 v121, s56, v121
    v_and_b32 v122, s56, v122
    v_and_b32 v123, s56, v123
    v_and_b32 v124, s56, v124
    v_and_b32 v125, s56, v125
    v_and_b32 v126, s56, v126
    v_and_b32 v127, s56, v127
    v_pk_add_f32 v[96:97], v[96:97], v[112:113]
    v_pk_add_f32 v[98:99], v[98:99], v[114:115]
    v_pk_add_f32 v[100:101], v[100:101], v[116:117]
    v_pk_add_f32 v[102:103], v[102:103], v[118:119]
    v_pk_add_f32 v[104:105], v[104:105], v[120:121]
    v_pk_add_f32 v[106:107], v[106:107], v[122:123]
    v_pk_add_f32 v[108:109], v[108:109], v[124:125]
    v_pk_add_f32 v[110:111], v[110:111], v[126:127]
    v_pk_add_f32 v[96:97], v[96:97], v[104:105]
    v_pk_add_f32 v[98:99], v[98:99], v[106:107]
    v_pk_add_f32 v[100:101], v[100:101], v[108:109]
    v_pk_add_f32 v[102:103], v[102:103], v[110:111]
    s_nop 0
    v_permlane16_swap_b32 v100, v101
    v_permlane16_swap_b32 v102, v103
    v_add_f32 v100, v100, v101
    v_add_f32 v102, v102, v103
    s_nop 1
    v_permlane32_swap_b32 v100, v102
    v_add_f32 v100, v100, v102
    v_permlane16_swap_b32 v96, v97
    v_permlane16_swap_b32 v98, v99
    v_add_f32 v96, v96, v97
    v_add_f32 v98, v98, v99
    s_nop 1
    v_permlane32_swap_b32 v96, v98
    v_add_f32 v96, v96, v98
    v_cvt_pk_bf16_f32 v100, v100, v100
    v_and_b32 v100, 0xffff0000, v100
    v_add_f32 v100, 1.0, v100
    v_cvt_pk_bf16_f32 v96, v96, v96
    v_and_b32 v96, 0xffff0000, v96
    v_cvt_pk_bf16_f32 v100, v100, v100
    v_and_b32 v100, 0xffff0000, v100
    v_mul_f32 v100, v100, v204
    v_cvt_pk_bf16_f32 v100, v100, v100
    v_and_b32 v100, 0xffff0000, v100
    v_add_f32 v96, v96, v100
    v_cvt_pk_bf16_f32 v96, v96, v96
    v_and_b32 v96, 0xffff0000, v96
    v_and_or_b32 v96, v96, s56, v5
    buffer_store_dword v96, v11, s[44:47], 0 offen sc1
    s_branch L_s1_done
L_s1_nocomb:
    s_waitcnt vmcnt(0)
    v_and_b32 v5, 0x7f7f7f7f, v4
    v_add_u32 v5, 0x4f2b1d35, v5
    v_and_b32 v4, 0x80808080, v4
    v_xor_b32 v4, v4, v5
    v_lshlrev_b32 v5, 3, v2
    v_lshrrev_b32 v5, v5, v4
    v_and_b32 v5, 0xff, v5
    s_nop 2
L_s1_done:
    s_barrier
    s_mov_b64 exec, 1
    global_load_dword v202, v205, s[24:25]
    s_mov_b64 exec, -1
    s_cmp_lt_u32 s8, 4
    s_cbranch_scc1 L_wo_only
    v_lshlrev_b32 v164, 16, v196
    v_and_b32 v165, 0xffff0000, v196
    v_lshlrev_b32 v166, 16, v197
    v_and_b32 v167, 0xffff0000, v197
    v_lshlrev_b32 v168, 16, v198
    v_and_b32 v169, 0xffff0000, v198
    v_lshlrev_b32 v170, 16, v199
    v_and_b32 v171, 0xffff0000, v199
    v_mul_f32 v172, 0xbfb8aa3b, v164
    v_mul_f32 v173, 0xbfb8aa3b, v165
    v_mul_f32 v174, 0xbfb8aa3b, v166
    v_mul_f32 v175, 0xbfb8aa3b, v167
    v_mul_f32 v176, 0xbfb8aa3b, v168
    v_mul_f32 v177, 0xbfb8aa3b, v169
    v_mul_f32 v178, 0xbfb8aa3b, v170
    v_mul_f32 v179, 0xbfb8aa3b, v171
    v_exp_f32 v172, v172
    v_exp_f32 v173, v173
    v_exp_f32 v174, v174
    v_exp_f32 v175, v175
    v_exp_f32 v176, v176
    v_exp_f32 v177, v177
    v_exp_f32 v178, v178
    v_exp_f32 v179, v179
    v_add_f32 v172, 1.0, v172
    v_add_f32 v173, 1.0, v173
    v_add_f32 v174, 1.0, v174
    v_add_f32 v175, 1.0, v175
    v_add_f32 v176, 1.0, v176
    v_add_f32 v177, 1.0, v177
    v_add_f32 v178, 1.0, v178
    v_add_f32 v179, 1.0, v179
    v_rcp_f32 v172, v172
    v_rcp_f32 v173, v173
    v_rcp_f32 v174, v174
    v_rcp_f32 v175, v175
    v_rcp_f32 v176, v176
    v_rcp_f32 v177, v177
    v_rcp_f32 v178, v178
    v_rcp_f32 v179, v179
    v_mul_f32 v164, v164, v172
    v_mul_f32 v165, v165, v173
    v_mul_f32 v166, v166, v174
    v_mul_f32 v167, v167, v175
    v_mul_f32 v168, v168, v176
    v_mul_f32 v169, v169, v177
    v_mul_f32 v170, v170, v178
    v_mul_f32 v171, v171, v179
    v_cvt_pk_bf16_f32 v160, v164, v165
    v_cvt_pk_bf16_f32 v161, v166, v167
    v_cvt_pk_bf16_f32 v162, v168, v169
    v_cvt_pk_bf16_f32 v163, v170, v171
    global_load_dwordx4 v[16:19], v206, s[36:37] offset:0 nt
    v_add_u32 v206, 6144, v206
    global_load_dwordx4 v[20:23], v206, s[36:37] nt
    v_add_u32 v206, 6144, v206
    global_load_dwordx4 v[24:27], v206, s[36:37] nt
    v_add_u32 v206, 6144, v206
    global_load_dwordx4 v[28:31], v206, s[36:37] nt
    v_add_u32 v206, 6144, v206
    global_load_dwordx4 v[32:35], v206, s[36:37] nt
    v_add_u32 v206, 6144, v206
    global_load_dwordx4 v[36:39], v206, s[36:37] nt
    v_add_u32 v206, 6144, v206
    global_load_dwordx4 v[40:43], v206, s[36:37] nt
    v_add_u32 v206, 6144, v206
    global_load_dwordx4 v[44:47], v206, s[36:37] nt
    s_waitcnt vmcnt(0)
    v_perm_b32 v48, v20, v16, s50
    v_perm_b32 v52, v20, v16, s51
    v_perm_b32 v56, v21, v17, s50
    v_perm_b32 v60, v21, v17, s51
    v_perm_b32 v64, v22, v18, s50
    v_perm_b32 v68, v22, v18, s51
    v_perm_b32 v72, v23, v19, s50
    v_perm_b32 v76, v23, v19, s51
    v_perm_b32 v49, v28, v24, s50
    v_perm_b32 v53, v28, v24, s51
    v_perm_b32 v57, v29, v25, s50
    v_perm_b32 v61, v29, v25, s51
    v_perm_b32 v65, v30, v26, s50
    v_perm_b32 v69, v30, v26, s51
    v_perm_b32 v73, v31, v27, s50
    v_perm_b32 v77, v31, v27, s51
    v_perm_b32 v50, v36, v32, s50
    v_perm_b32 v54, v36, v32, s51
    v_perm_b32 v58, v37, v33, s50
    v_perm_b32 v62, v37, v33, s51
    v_perm_b32 v66, v38, v34, s50
    v_perm_b32 v70, v38, v34, s51
    v_perm_b32 v74, v39, v35, s50
    v_perm_b32 v78, v39, v35, s51
    v_perm_b32 v51, v44, v40, s50
    v_perm_b32 v55, v44, v40, s51
    v_perm_b32 v59, v45, v41, s50
    v_perm_b32 v63, v45, v41, s51
    v_perm_b32 v67, v46, v42, s50
    v_perm_b32 v71, v46, v42, s51
    v_perm_b32 v75, v47, v43, s50
    v_perm_b32 v79, v47, v43, s51
    v_mfma_f32_16x16x32_bf16 v[128:131], v[160:163], v[48:51], 0
    v_mfma_f32_16x16x32_bf16 v[132:135], v[160:163], v[52:55], 0
    v_mfma_f32_16x16x32_bf16 v[136:139], v[160:163], v[56:59], 0
    v_mfma_f32_16x16x32_bf16 v[140:143], v[160:163], v[60:63], 0
    v_mfma_f32_16x16x32_bf16 v[144:147], v[160:163], v[64:67], 0
    v_mfma_f32_16x16x32_bf16 v[148:151], v[160:163], v[68:71], 0
    v_mfma_f32_16x16x32_bf16 v[152:155], v[160:163], v[72:75], 0
    v_mfma_f32_16x16x32_bf16 v[156:159], v[160:163], v[76:79], 0
    s_nop 0
    v_cndmask_b32 v172, v128, v129, s[52:53]
    v_cndmask_b32 v173, v132, v133, s[52:53]
    v_cndmask_b32 v174, v136, v137, s[52:53]
    v_cndmask_b32 v175, v140, v141, s[52:53]
    v_cndmask_b32 v176, v144, v145, s[52:53]
    v_cndmask_b32 v177, v148, v149, s[52:53]
    v_cndmask_b32 v178, v152, v153, s[52:53]
    v_cndmask_b32 v179, v156, v157, s[52:53]
    s_mov_b64 exec, 0xffff
    ds_write_b128 v88, v[172:175] offset:0
    ds_write_b128 v88, v[176:179] offset:16
    s_mov_b64 exec, -1
    s_waitcnt lgkmcnt(0)
    s_barrier
    s_cmp_lg_u32 s3, 0
    s_cbranch_scc1 L_wo_only
    ds_read_b128 v[180:183], v89 offset:0
    ds_read_b128 v[184:187], v89 offset:256
    ds_read_b128 v[188:191], v89 offset:512
    ds_read_b128 v[192:195], v89 offset:768
    s_waitcnt lgkmcnt(2)
    v_pk_add_f32 v[180:181], v[180:181], v[184:185]
    v_pk_add_f32 v[182:183], v[182:183], v[186:187]
    s_waitcnt lgkmcnt(0)
    v_pk_add_f32 v[188:189], v[188:189], v[192:193]
    v_pk_add_f32 v[190:191], v[190:191], v[194:195]
    v_pk_add_f32 v[180:181], v[180:181], v[188:189]
    v_pk_add_f32 v[182:183], v[182:183], v[190:191]
    s_nop 0
    v_permlane16_swap_b32 v180, v181
    v_permlane16_swap_b32 v182, v183
    v_add_f32 v180, v180, v181
    v_add_f32 v182, v182, v183
    s_nop 1
    v_permlane32_swap_b32 v180, v182
    v_add_f32 v180, v180, v182
    v_cvt_pk_bf16_f32 v180, v180, v180
    v_and_b32 v180, 0xffff0000, v180
    s_lshl_b32 s6, s9, 8
    s_add_u32 s6, s6, 8192
    v_add_u32 v200, s6, v90
    v_and_or_b32 v180, v180, s56, v5
    buffer_store_dword v180, v200, s[44:47], 0 offen sc1
    s_nop 1
L_wo_only:
    s_lshl_b32 s6, s5, 4
    s_add_u32 s6, s6, s48
    s_add_u32 s6, s6, 46080
    v_mov_b32 v200, s6
    s_mov_b64 exec, 1
    s_nop 1
    s_branch L_poll_2_p
L_poll_2_s:
    s_mov_b32 s63, 3
    s_waitcnt vmcnt(0)
    buffer_load_dwordx4 v[180:183], v200, s[44:47], s49 offen offset:0 sc1
    s_waitcnt vmcnt(0)
    v_perm_b32 v13, v181, v180, s54
    v_perm_b32 v14, v183, v182, s55
    v_bitop3_b32 v15, v13, v14, v4 bitop3:0x56
    v_cmp_ne_u32 vcc, 0, v15
    s_mov_b64 exec, vcc
    s_cbranch_vccz L_poll_2_d
L_poll_2_p:
L_poll_2:
    buffer_load_dwordx4 v[180:183], v200, s[44:47], 0 offen offset:0 sc1
    s_add_u32 s57, s57, 1
    s_cmp_gt_u32 s57, 200000
    s_cbranch_scc1 L_end
    s_and_b32 s59, s57, s63
    s_cbranch_scc0 L_poll_2_s
    s_waitcnt vmcnt(0)
    v_perm_b32 v13, v181, v180, s54
    v_perm_b32 v14, v183, v182, s55
    v_bitop3_b32 v15, v13, v14, v4 bitop3:0x56
    v_cmp_ne_u32 vcc, 0, v15
    s_mov_b64 exec, vcc
    s_cbranch_vccnz L_poll_2
L_poll_2_d:
    s_mov_b64 exec, -1
    global_load_dwordx4 v[96:99], v205, s[24:25] offset:0 nt
    global_load_dwordx4 v[112:115], v205, s[24:25] offset:1024 nt
    v_add_u32 v205, 8192, v205
    global_load_dwordx4 v[100:103], v205, s[24:25] nt
    global_load_dwordx4 v[116:119], v205, s[24:25] offset:1024 nt
    v_add_u32 v205, 8192, v205
    global_load_dwordx4 v[104:107], v205, s[24:25] nt
    global_load_dwordx4 v[120:123], v205, s[24:25] offset:1024 nt
    v_add_u32 v205, 8192, v205
    global_load_dwordx4 v[108:111], v205, s[24:25] nt
    global_load_dwordx4 v[124:127], v205, s[24:25] offset:1024 nt
    s_nop 0
L_s4:
    s_lshl_b32 s6, s3, 8
    s_add_u32 s6, s6, s48
    s_add_u32 s6, s6, 40960
    v_lshlrev_b32 v200, 5, v10
    v_add_u32 v200, s6, v200
    s_lshl_b32 s6, s4, 11
    s_lshl_b32 s7, s8, 8
    s_add_u32 s6, s6, s7
    s_add_u32 s6, s6, 16384
    v_add_u32 v204, s6, v90
    s_waitcnt vmcnt(0)
    v_perm_b32 v48, v100, v96, s50
    v_perm_b32 v52, v100, v96, s51
    v_perm_b32 v56, v101, v97, s50
    v_perm_b32 v60, v101, v97, s51
    v_perm_b32 v64, v102, v98, s50
    v_perm_b32 v68, v102, v98, s51
    v_perm_b32 v72, v103, v99, s50
    v_perm_b32 v76, v103, v99, s51
    v_perm_b32 v49, v108, v104, s50
    v_perm_b32 v53, v108, v104, s51
    v_perm_b32 v57, v109, v105, s50
    v_perm_b32 v61, v109, v105, s51
    v_perm_b32 v65, v110, v106, s50
    v_perm_b32 v69, v110, v106, s51
    v_perm_b32 v73, v111, v107, s50
    v_perm_b32 v77, v111, v107, s51
    v_perm_b32 v50, v116, v112, s50
    v_perm_b32 v54, v116, v112, s51
    v_perm_b32 v58, v117, v113, s50
    v_perm_b32 v62, v117, v113, s51
    v_perm_b32 v66, v118, v114, s50
    v_perm_b32 v70, v118, v114, s51
    v_perm_b32 v74, v119, v115, s50
    v_perm_b32 v78, v119, v115, s51
    v_perm_b32 v51, v124, v120, s50
    v_perm_b32 v55, v124, v120, s51
    v_perm_b32 v59, v125, v121, s50
    v_perm_b32 v63, v125, v121, s51
    v_perm_b32 v67, v126, v122, s50
    v_perm_b32 v71, v126, v122, s51
    v_perm_b32 v75, v127, v123, s50
    v_perm_b32 v79, v127, v123, s51
    s_mov_b32 exec_lo, 0x00030003
    s_mov_b32 exec_hi, 0x00030003
    s_nop 0
    s_branch L_poll_3_p
L_poll_3_s:
    s_mov_b32 s63, 3
    s_waitcnt vmcnt(0)
    buffer_load_dwordx4 v[180:183], v200, s[44:47], s49 offen offset:0 sc1
    buffer_load_dwordx4 v[184:187], v200, s[44:47], s49 offen offset:16 sc1
    s_waitcnt vmcnt(1)
    v_perm_b32 v13, v181, v180, s54
    v_perm_b32 v14, v183, v182, s55
    v_bitop3_b32 v15, v13, v14, v4 bitop3:0x56
    s_waitcnt vmcnt(0)
    v_perm_b32 v13, v185, v184, s54
    v_perm_b32 v14, v187, v186, s55
    v_bitop3_b32 v13, v13, v14, v4 bitop3:0x56
    v_or_b32 v15, v15, v13
    v_cmp_ne_u32 vcc, 0, v15
    s_mov_b64 exec, vcc
    s_cbranch_vccz L_poll_3_d
L_poll_3_p:
L_poll_3:
    buffer_load_dwordx4 v[180:183], v200, s[44:47], 0 offen offset:0 sc1
    buffer_load_dwordx4 v[184:187], v200, s[44:47], 0 offen offset:16 sc1
    s_add_u32 s57, s57, 1
    s_cmp_gt_u32 s57, 200000
    s_cbranch_scc1 L_end
    s_and_b32 s59, s57, s63
    s_cbranch_scc0 L_poll_3_s
    s_waitcnt vmcnt(1)
    v_perm_b32 v13, v181, v180, s54
    v_perm_b32 v14, v183, v182, s55
    v_bitop3_b32 v15, v13, v14, v4 bitop3:0x56
    s_waitcnt vmcnt(0)
    v_perm_b32 v13, v185, v184, s54
    v_perm_b32 v14, v187, v186, s55
    v_bitop3_b32 v13, v13, v14, v4 bitop3:0x56
    v_or_b32 v15, v15, v13
    v_cmp_ne_u32 vcc, 0, v15
    s_mov_b64 exec, vcc
    s_cbranch_vccnz L_poll_3
L_poll_3_d:
    s_mov_b64 exec, -1
    v_perm_b32 v160, v181, v180, s51
    v_perm_b32 v161, v183, v182, s51
    v_perm_b32 v162, v185, v184, s51
    v_perm_b32 v163, v187, v186, s51
    s_nop 1
    v_mfma_f32_16x16x32_bf16 v[128:131], v[160:163], v[48:51], 0
    v_mfma_f32_16x16x32_bf16 v[132:135], v[160:163], v[52:55], 0
    v_mfma_f32_16x16x32_bf16 v[136:139], v[160:163], v[56:59], 0
    v_mfma_f32_16x16x32_bf16 v[140:143], v[160:163], v[60:63], 0
    v_mfma_f32_16x16x32_bf16 v[144:147], v[160:163], v[64:67], 0
    v_mfma_f32_16x16x32_bf16 v[148:151], v[160:163], v[68:71], 0
    v_mfma_f32_16x16x32_bf16 v[152:155], v[160:163], v[72:75], 0
    v_mfma_f32_16x16x32_bf16 v[156:159], v[160:163], v[76:79], 0
    s_nop 0
    v_cndmask_b32 v172, v128, v129, s[52:53]
    v_cndmask_b32 v173, v132, v133, s[52:53]
    v_cndmask_b32 v174, v136, v137, s[52:53]
    v_cndmask_b32 v175, v140, v141, s[52:53]
    v_cndmask_b32 v176, v144, v145, s[52:53]
    v_cndmask_b32 v177, v148, v149, s[52:53]
    v_cndmask_b32 v178, v152, v153, s[52:53]
    v_cndmask_b32 v179, v156, v157, s[52:53]
    s_mov_b64 exec, 0xffff
    ds_write_b128 v88, v[172:175] offset:4096
    ds_write_b128 v88, v[176:179] offset:4112
    s_mov_b64 exec, -1
    s_waitcnt vmcnt(0) lgkmcnt(0)
    s_barrier
    s_cmp_lg_u32 s3, 0
    s_cbranch_scc1 L_end
    ds_read_b128 v[180:183], v89 offset:4096
    ds_read_b128 v[184:187], v89 offset:4352
    ds_read_b128 v[188:191], v89 offset:4608
    ds_read_b128 v[192:195], v89 offset:4864
    s_waitcnt lgkmcnt(2)
    v_pk_add_f32 v[180:181], v[180:181], v[184:185]
    v_pk_add_f32 v[182:183], v[182:183], v[186:187]
    s_waitcnt lgkmcnt(0)
    v_pk_add_f32 v[188:189], v[188:189], v[192:193]
    v_pk_add_f32 v[190:191], v[190:191], v[194:195]
    v_pk_add_f32 v[180:181], v[180:181], v[188:189]
    v_pk_add_f32 v[182:183], v[182:183], v[190:191]
    s_nop 0
    v_permlane16_swap_b32 v180, v181
    v_permlane16_swap_b32 v182, v183
    v_add_f32 v180, v180, v181
    v_add_f32 v182, v182, v183
    s_nop 1
    v_permlane32_swap_b32 v180, v182
    v_add_f32 v180, v180, v182
    v_and_or_b32 v180, v180, s56, v5
    buffer_store_dword v180, v204, s[44:47], 0 offen sc1
    s_endpgm
L_roleWQ:
    s_mov_b32 s49, 1048576
    s_mov_b32 s50, 0x05040100
    s_mov_b32 s51, 0x07060302
    s_mov_b32 s52, 0xff00ff00
    s_mov_b32 s53, 0xff00ff00
    s_mov_b32 s54, 0x0c0c0400
    s_mov_b32 s55, 0x04000c0c
    s_mov_b32 s56, 0xffffff00
    s_mov_b32 s57, 0
    s_mov_b32 s63, 255
    s_mov_b32 s84, 0x07060500
    s_mov_b32 s85, 0x07060501
    s_mov_b32 s86, 0x07060502
    s_mov_b32 s87, 0x07060503
    s_lshl_b32 s6, s3, 9
    v_lshlrev_b32 v88, 8, v7
    v_lshl_add_u32 v88, v8, 5, v88
    v_add_u32 v88, s6, v88
    v_lshlrev_b32 v89, 10, v2
    v_lshl_add_u32 v89, v3, 4, v89
    v_lshlrev_b32 v90, 2, v2
    v_lshl_add_u32 v90, v3, 4, v90
    s_lshl_b32 s6, s3, 7
    v_lshrrev_b32 v91, 1, v90
    v_add_u32 v91, s6, v91
    v_lshlrev_b32 v92, 4, v10
    v_add_u32 v92, s6, v92
    global_load_ushort v168, v91, s[16:17]
    s_lshl_b32 s6, s9, 8
    s_add_u32 s6, s6, 4096
    v_lshlrev_b32 v171, 5, v10
    v_add_u32 v171, s6, v171
    s_lshr_b32 s6, s5, 1
    s_lshl_b32 s6, s6, 11
    s_and_b32 s7, s5, 1
    s_lshl_b32 s7, s7, 2
    s_add_u32 s7, s7, s3
    s_lshl_b32 s7, s7, 8
    s_add_u32 s6, s6, s7
    s_add_u32 s6, s6, s48
    s_add_u32 s6, s6, 32768
    v_add_u32 v173, s6, v90
    s_lshl_b32 s6, s3, 10
    v_lshlrev_b32 v174, 8, v2
    v_lshl_add_u32 v174, v3, 4, v174
    v_add_u32 v174, s6, v174
    s_cmp_ge_u32 s5, 4
    s_cselect_b32 s10, s30, s28
    s_cselect_b32 s11, s31, s29
    s_and_b32 s6, s5, 3
    s_lshl_b32 s9, s4, 2
    s_add_u32 s9, s9, s6
    s_mul_i32 s6, s3, 229376
    s_lshl_b32 s7, s9, 7
    s_add_u32 s6, s6, s7
    v_mul_u32_u24 v172, 28672, v9
    v_lshl_add_u32 v172, v8, 4, v172
    v_add_u32 v172, s6, v172
    s_mov_b64 exec, 1
    global_load_dword v169, v6, s[10:11]
    s_mov_b64 exec, -1
    s_waitcnt vmcnt(9)
    v_perm_b32 v48, v20, v16, s50
    v_perm_b32 v52, v20, v16, s51
    v_perm_b32 v56, v21, v17, s50
    v_perm_b32 v60, v21, v17, s51
    v_perm_b32 v64, v22, v18, s50
    v_perm_b32 v68, v22, v18, s51
    v_perm_b32 v72, v23, v19, s50
    v_perm_b32 v76, v23, v19, s51
    s_waitcnt vmcnt(7)
    v_perm_b32 v49, v28, v24, s50
    v_perm_b32 v53, v28, v24, s51
    v_perm_b32 v57, v29, v25, s50
    v_perm_b32 v61, v29, v25, s51
    v_perm_b32 v65, v30, v26, s50
    v_perm_b32 v69, v30, v26, s51
    v_perm_b32 v73, v31, v27, s50
    v_perm_b32 v77, v31, v27, s51
    s_waitcnt vmcnt(5)
    v_perm_b32 v50, v36, v32, s50
    v_perm_b32 v54, v36, v32, s51
    v_perm_b32 v58, v37, v33, s50
    v_perm_b32 v62, v37, v33, s51
    v_perm_b32 v66, v38, v34, s50
    v_perm_b32 v70, v38, v34, s51
    v_perm_b32 v74, v39, v35, s50
    v_perm_b32 v78, v39, v35, s51
    s_waitcnt vmcnt(3)
    v_perm_b32 v51, v44, v40, s50
    v_perm_b32 v55, v44, v40, s51
    v_perm_b32 v59, v45, v41, s50
    v_perm_b32 v63, v45, v41, s51
    v_perm_b32 v67, v46, v42, s50
    v_perm_b32 v71, v46, v42, s51
    v_perm_b32 v75, v47, v43, s50
    v_perm_b32 v79, v47, v43, s51
    s_waitcnt vmcnt(0)
    v_and_b32 v5, 0x7f7f7f7f, v4
    v_add_u32 v5, 0x4f2b1d35, v5
    v_and_b32 v4, 0x80808080, v4
    v_xor_b32 v4, v4, v5
    v_lshlrev_b32 v5, 3, v2
    v_lshrrev_b32 v5, v5, v4
    v_and_b32 v5, 0xff, v5
    s_mov_b32 exec_lo, 0x00030003
    s_mov_b32 exec_hi, 0x00030003
    s_nop 0
L_poll_4:
    buffer_load_dwordx4 v[132:135], v171, s[44:47], 0 offen offset:0 sc1
    buffer_load_dwordx4 v[136:139], v171, s[44:47], 0 offen offset:16 sc1
    s_add_u32 s57, s57, 1
    s_cmp_gt_u32 s57, 200000
    s_cbranch_scc1 L_end
    s_waitcnt vmcnt(1)
    v_perm_b32 v13, v133, v132, s54
    v_perm_b32 v14, v135, v134, s55
    v_bitop3_b32 v15, v13, v14, v4 bitop3:0x56
    s_waitcnt vmcnt(0)
    v_perm_b32 v13, v137, v136, s54
    v_perm_b32 v14, v139, v138, s55
    v_bitop3_b32 v13, v13, v14, v4 bitop3:0x56
    v_or_b32 v15, v15, v13
    v_cmp_ne_u32 vcc, 0, v15
    s_mov_b64 exec, vcc
    s_cbranch_vccnz L_poll_4
    s_mov_b64 exec, -1
    v_perm_b32 v128, v133, v132, s51
    v_perm_b32 v129, v135, v134, s51
    v_perm_b32 v130, v137, v136, s51
    v_perm_b32 v131, v139, v138, s51
    s_nop 1
    v_mfma_f32_16x16x32_bf16 v[96:99], v[128:131], v[48:51], 0
    v_mfma_f32_16x16x32_bf16 v[100:103], v[128:131], v[52:55], 0
    v_mfma_f32_16x16x32_bf16 v[104:107], v[128:131], v[56:59], 0
    v_mfma_f32_16x16x32_bf16 v[108:111], v[128:131], v[60:63], 0
    v_mfma_f32_16x16x32_bf16 v[112:115], v[128:131], v[64:67], 0
    v_mfma_f32_16x16x32_bf16 v[116:119], v[128:131], v[68:71], 0
    v_mfma_f32_16x16x32_bf16 v[120:123], v[128:131], v[72:75], 0
    v_mfma_f32_16x16x32_bf16 v[124:127], v[128:131], v[76:79], 0
    s_nop 0
    v_cndmask_b32 v148, v96, v97, s[52:53]
    v_cndmask_b32 v149, v100, v101, s[52:53]
    v_cndmask_b32 v150, v104, v105, s[52:53]
    v_cndmask_b32 v151, v108, v109, s[52:53]
    v_cndmask_b32 v152, v112, v113, s[52:53]
    v_cndmask_b32 v153, v116, v117, s[52:53]
    v_cndmask_b32 v154, v120, v121, s[52:53]
    v_cndmask_b32 v155, v124, v125, s[52:53]
    s_mov_b64 exec, 0xffff
    ds_write_b128 v88, v[148:151] offset:0
    ds_write_b128 v88, v[152:155] offset:16
    s_mov_b64 exec, -1
    s_waitcnt vmcnt(0) lgkmcnt(0)
    s_barrier
    s_cmp_ge_u32 s3, 4
    s_cbranch_scc1 L_wq_skip
    ds_read_b128 v[132:135], v174 offset:0
    s_waitcnt lgkmcnt(0)
    v_permlane16_swap_b32 v132, v133
    v_permlane16_swap_b32 v134, v135
    v_add_f32 v132, v132, v133
    v_add_f32 v134, v134, v135
    s_nop 1
    v_permlane32_swap_b32 v132, v134
    v_add_f32 v132, v132, v134
    v_add_u32 v132, 0x80, v132
    v_and_or_b32 v132, v132, s56, v5
    buffer_store_dword v132, v173, s[44:47], 0 offen
    buffer_store_dword v132, v173, s[44:47], s49 offen sc1
    s_nop 0
L_wq_skip:
    s_cmp_eq_u32 s4, 7
    s_cbranch_scc1 L_end
    s_lshl_b32 s6, s5, 4
    s_add_u32 s6, s6, s48
    s_add_u32 s6, s6, 46080
    v_mov_b32 v171, s6
    s_mov_b64 exec, 1
    s_nop 1
    s_branch L_poll_5_p
L_poll_5_s:
    s_mov_b32 s63, 3
    s_waitcnt vmcnt(0)
    buffer_load_dwordx4 v[132:135], v171, s[44:47], s49 offen offset:0 sc1
    s_waitcnt vmcnt(0)
    v_perm_b32 v13, v133, v132, s54
    v_perm_b32 v14, v135, v134, s55
    v_bitop3_b32 v15, v13, v14, v4 bitop3:0x56
    v_cmp_ne_u32 vcc, 0, v15
    s_mov_b64 exec, vcc
    s_cbranch_vccz L_poll_5_d
L_poll_5_p:
L_poll_5:
    buffer_load_dwordx4 v[132:135], v171, s[44:47], 0 offen offset:0 sc1
    s_add_u32 s57, s57, 1
    s_cmp_gt_u32 s57, 200000
    s_cbranch_scc1 L_end
    s_and_b32 s59, s57, s63
    s_cbranch_scc0 L_poll_5_s
    s_waitcnt vmcnt(0)
    v_perm_b32 v13, v133, v132, s54
    v_perm_b32 v14, v135, v134, s55
    v_bitop3_b32 v15, v13, v14, v4 bitop3:0x56
    v_cmp_ne_u32 vcc, 0, v15
    s_mov_b64 exec, vcc
    s_cbranch_vccnz L_poll_5
L_poll_5_d:
    s_mov_b64 exec, -1
    global_load_dwordx4 v[16:19], v172, s[10:11] offset:0 nt
    global_load_dwordx4 v[20:23], v172, s[10:11] offset:3584 nt
    v_add_u32 v172, 7168, v172
    global_load_dwordx4 v[24:27], v172, s[10:11] nt
    global_load_dwordx4 v[28:31], v172, s[10:11] offset:3584 nt
    v_add_u32 v172, 7168, v172
    global_load_dwordx4 v[32:35], v172, s[10:11] nt
    global_load_dwordx4 v[36:39], v172, s[10:11] offset:3584 nt
    v_add_u32 v172, 7168, v172
    global_load_dwordx4 v[40:43], v172, s[10:11] nt
    global_load_dwordx4 v[44:47], v172, s[10:11] offset:3584 nt
    s_nop 0
L_gu_go:
    s_lshl_b32 s6, s3, 8
    s_add_u32 s6, s6, 8192
    v_lshlrev_b32 v171, 4, v3
    v_add_u32 v171, s6, v171
    v_add_u32 v11, 4096, v171
    s_and_b32 s6, s5, 3
    s_lshl_b32 s6, s6, 1
    s_lshr_b32 s7, s5, 2
    s_add_u32 s6, s6, s7
    s_lshl_b32 s6, s6, 8
    s_add_u32 s6, s6, s48
    s_add_u32 s6, s6, 43008
    v_add_u32 v172, s6, v90
    s_waitcnt vmcnt(0)
    v_perm_b32 v48, v20, v16, s50
    v_perm_b32 v52, v20, v16, s51
    v_perm_b32 v56, v21, v17, s50
    v_perm_b32 v60, v21, v17, s51
    v_perm_b32 v64, v22, v18, s50
    v_perm_b32 v68, v22, v18, s51
    v_perm_b32 v72, v23, v19, s50
    v_perm_b32 v76, v23, v19, s51
    v_perm_b32 v49, v28, v24, s50
    v_perm_b32 v53, v28, v24, s51
    v_perm_b32 v57, v29, v25, s50
    v_perm_b32 v61, v29, v25, s51
    v_perm_b32 v65, v30, v26, s50
    v_perm_b32 v69, v30, v26, s51
    v_perm_b32 v73, v31, v27, s50
    v_perm_b32 v77, v31, v27, s51
    v_perm_b32 v50, v36, v32, s50
    v_perm_b32 v54, v36, v32, s51
    v_perm_b32 v58, v37, v33, s50
    v_perm_b32 v62, v37, v33, s51
    v_perm_b32 v66, v38, v34, s50
    v_perm_b32 v70, v38, v34, s51
    v_perm_b32 v74, v39, v35, s50
    v_perm_b32 v78, v39, v35, s51
    v_perm_b32 v51, v44, v40, s50
    v_perm_b32 v55, v44, v40, s51
    v_perm_b32 v59, v45, v41, s50
    v_perm_b32 v63, v45, v41, s51
    v_perm_b32 v67, v46, v42, s50
    v_perm_b32 v71, v46, v42, s51
    v_perm_b32 v75, v47, v43, s50
    v_perm_b32 v79, v47, v43, s51
    s_nop 2
L_poll_6:
    buffer_load_dwordx4 v[156:159], v171, s[44:47], 0 offen offset:0 sc1
    buffer_load_dwordx4 v[160:163], v171, s[44:47], 0 offen offset:2048 sc1
    buffer_load_dwordx4 v[164:167], v11, s[44:47], 0 offen offset:0 sc1
    s_add_u32 s57, s57, 1
    s_cmp_gt_u32 s57, 200000
    s_cbranch_scc1 L_end
    s_waitcnt vmcnt(2)
    v_perm_b32 v13, v157, v156, s54
    v_perm_b32 v14, v159, v158, s55
    v_bitop3_b32 v15, v13, v14, v4 bitop3:0x56
    s_waitcnt vmcnt(1)
    v_perm_b32 v13, v161, v160, s54
    v_perm_b32 v14, v163, v162, s55
    v_bitop3_b32 v13, v13, v14, v4 bitop3:0x56
    v_or_b32 v15, v15, v13
    s_waitcnt vmcnt(0)
    v_perm_b32 v13, v165, v164, s54
    v_perm_b32 v14, v167, v166, s55
    v_bitop3_b32 v13, v13, v14, v4 bitop3:0x56
    v_or_b32 v15, v15, v13
    v_cmp_ne_u32 vcc, 0, v15
    s_mov_b64 exec, vcc
    s_cbranch_vccnz L_poll_6
    s_mov_b64 exec, -1
    s_mov_b32 vcc_lo, 4294901760
    s_mov_b32 vcc_hi, 0
    v_cndmask_b32 v156, v156, v157, vcc
    v_cndmask_b32 v160, v160, v161, vcc
    v_cndmask_b32 v164, v164, v165, vcc
    s_mov_b32 vcc_lo, 0
    s_mov_b32 vcc_hi, 65535
    v_cndmask_b32 v156, v156, v158, vcc
    v_cndmask_b32 v160, v160, v162, vcc
    v_cndmask_b32 v164, v164, v166, vcc
    s_mov_b32 vcc_lo, 0
    s_mov_b32 vcc_hi, 4294901760
    v_cndmask_b32 v156, v156, v159, vcc
    v_cndmask_b32 v160, v160, v163, vcc
    v_cndmask_b32 v164, v164, v167, vcc
    v_and_b32 v156, 0xffff0000, v156
    v_and_b32 v160, 0xffff0000, v160
    v_and_b32 v164, 0xffff0000, v164
    v_add_f32 v164, 1.0, v164
    v_cvt_pk_bf16_f32 v164, v164, v164
    v_and_b32 v164, 0xffff0000, v164
    v_lshlrev_b32 v168, 16, v168
    v_lshlrev_b32 v171, 12, v2
    v_lshl_add_u32 v171, v3, 4, v171
    s_lshl_b32 s6, s3, 8
    s_add_u32 s6, s6, 16384
    v_add_u32 v171, s6, v171
    s_lshl_b32 s6, s3, 3
    v_lshlrev_b32 v11, 2, v2
    v_add_u32 v11, s6, v11
    s_nop 2
L_poll_7:
    buffer_load_dwordx4 v[132:135], v171, s[44:47], 0 offen offset:0 sc1
    buffer_load_dwordx4 v[136:139], v171, s[44:47], 0 offen offset:2048 sc1
    s_add_u32 s57, s57, 1
    s_cmp_gt_u32 s57, 200000
    s_cbranch_scc1 L_end
    s_waitcnt vmcnt(1)
    v_perm_b32 v13, v133, v132, s54
    v_perm_b32 v14, v135, v134, s55
    v_bitop3_b32 v15, v13, v14, v4 bitop3:0x56
    s_waitcnt vmcnt(0)
    v_perm_b32 v13, v137, v136, s54
    v_perm_b32 v14, v139, v138, s55
    v_bitop3_b32 v13, v13, v14, v4 bitop3:0x56
    v_or_b32 v15, v15, v13
    v_cmp_ne_u32 vcc, 0, v15
    s_mov_b64 exec, vcc
    s_cbranch_vccnz L_poll_7
    s_mov_b64 exec, -1
    v_pk_add_f32 v[148:149], v[132:133], v[136:137]
    v_pk_add_f32 v[150:151], v[134:135], v[138:139]
    s_nop 0
    v_permlane16_swap_b32 v148, v149
    v_permlane16_swap_b32 v150, v151
    v_add_f32 v148, v148, v149
    v_add_f32 v150, v150, v151
    s_nop 1
    v_permlane32_swap_b32 v148, v150
    v_add_f32 v148, v148, v150
    v_cvt_pk_bf16_f32 v148, v148, v148
    v_and_b32 v148, 0xffff0000, v148
    v_mul_f32 v148, v148, v156
    v_cvt_pk_bf16_f32 v148, v148, v148
    v_and_b32 v148, 0xffff0000, v148
    v_add_f32 v168, v168, v148
    v_cvt_pk_bf16_f32 v168, v168, v168
    v_and_b32 v168, 0xffff0000, v168
    v_mul_f32 v14, v168, v168
    s_nop 0
    v_add_f32_dpp v13, v168, v168 row_ror:8 row_mask:0xf bank_mask:0xf
    v_add_f32_dpp v14, v14, v14 row_ror:8 row_mask:0xf bank_mask:0xf
    s_nop 0
    v_add_f32_dpp v13, v13, v13 row_ror:4 row_mask:0xf bank_mask:0xf
    v_add_f32_dpp v14, v14, v14 row_ror:4 row_mask:0xf bank_mask:0xf
    s_nop 0
    v_add_f32_dpp v13, v13, v13 row_ror:2 row_mask:0xf bank_mask:0xf
    v_add_f32_dpp v14, v14, v14 row_ror:2 row_mask:0xf bank_mask:0xf
    s_nop 0
    v_add_f32_dpp v13, v13, v13 row_ror:1 row_mask:0xf bank_mask:0xf
    v_add_f32_dpp v14, v14, v14 row_ror:1 row_mask:0xf bank_mask:0xf
    s_nop 1
    v_permlane16_swap_b32 v13, v14
    v_add_f32 v13, v13, v14
    v_mov_b32 v14, v13
    s_nop 1
    v_permlane32_swap_b32 v13, v14
    v_add_f32 v13, v13, v14
    s_mov_b64 exec, 0x10001
    ds_write_b32 v11, v13 offset:8192
    s_mov_b64 exec, -1
    s_waitcnt lgkmcnt(0)
    s_barrier
    ds_read_b128 v[96:99], v6 offset:8192
    ds_read_b128 v[100:103], v6 offset:8208
    ds_read_b128 v[104:107], v6 offset:8224
    ds_read_b128 v[108:111], v6 offset:8240
    s_waitcnt lgkmcnt(2)
    v_pk_add_f32 v[96:97], v[96:97], v[98:99]
    v_pk_add_f32 v[100:101], v[100:101], v[102:103]
    s_waitcnt lgkmcnt(0)
    v_pk_add_f32 v[104:105], v[104:105], v[106:107]
    v_pk_add_f32 v[108:109], v[108:109], v[110:111]
    v_pk_add_f32 v[96:97], v[96:97], v[100:101]
    v_pk_add_f32 v[104:105], v[104:105], v[108:109]
    v_pk_add_f32 v[96:97], v[96:97], v[104:105]
    v_mul_f32 v169, 0x3b000000, v96
    v_mul_f32 v13, 0x3b000000, v97
    v_fma_f32 v13, -v169, v169, v13
    v_max_f32 v13, 0, v13
    v_cvt_pk_bf16_f32 v169, v169, v169
    v_and_b32 v169, 0xffff0000, v169
    v_cvt_pk_bf16_f32 v13, v13, v13
    v_and_b32 v13, 0xffff0000, v13
    v_add_f32 v13, 0x3727c5ac, v13
    v_cvt_pk_bf16_f32 v13, v13, v13
    v_and_b32 v13, 0xffff0000, v13
    v_sqrt_f32 v13, v13
    s_nop 0
    v_cvt_pk_bf16_f32 v13, v13, v13
    v_and_b32 v13, 0xffff0000, v13
    v_rcp_f32 v170, v13
    v_sub_f32 v168, v168, v169
    v_cvt_pk_bf16_f32 v168, v168, v168
    v_and_b32 v168, 0xffff0000, v168
    v_mul_f32 v168, v168, v170
    v_cvt_pk_bf16_f32 v168, v168, v168
    v_and_b32 v168, 0xffff0000, v168
    v_mul_f32 v168, v168, v164
    v_cvt_pk_bf16_f32 v168, v168, v168
    v_and_b32 v168, 0xffff0000, v168
    v_add_f32 v168, v168, v160
    v_cvt_pk_bf16_f32 v168, v168, v168
    ds_write_b16 v91, v168 offset:13312
    s_waitcnt lgkmcnt(0)
    ds_read_b128 v[128:131], v92 offset:13312
    s_waitcnt lgkmcnt(0)
    v_mfma_f32_16x16x32_bf16 v[96:99], v[128:131], v[48:51], 0
    v_mfma_f32_16x16x32_bf16 v[100:103], v[128:131], v[52:55], 0
    v_mfma_f32_16x16x32_bf16 v[104:107], v[128:131], v[56:59], 0
    v_mfma_f32_16x16x32_bf16 v[108:111], v[128:131], v[60:63], 0
    v_mfma_f32_16x16x32_bf16 v[112:115], v[128:131], v[64:67], 0
    v_mfma_f32_16x16x32_bf16 v[116:119], v[128:131], v[68:71], 0
    v_mfma_f32_16x16x32_bf16 v[120:123], v[128:131], v[72:75], 0
    v_mfma_f32_16x16x32_bf16 v[124:127], v[128:131], v[76:79], 0
    s_nop 0
    v_cndmask_b32 v148, v96, v97, s[52:53]
    v_cndmask_b32 v149, v100, v101, s[52:53]
    v_cndmask_b32 v150, v104, v105, s[52:53]
    v_cndmask_b32 v151, v108, v109, s[52:53]
    v_cndmask_b32 v152, v112, v113, s[52:53]
    v_cndmask_b32 v153, v116, v117, s[52:53]
    v_cndmask_b32 v154, v120, v121, s[52:53]
    v_cndmask_b32 v155, v124, v125, s[52:53]
    s_mov_b64 exec, 0xffff
    ds_write_b128 v88, v[148:151] offset:4096
    ds_write_b128 v88, v[152:155] offset:4112
    s_mov_b64 exec, -1
    s_waitcnt vmcnt(0) lgkmcnt(0)
    s_barrier
    s_cmp_lg_u32 s3, 0
    s_cbranch_scc1 L_end
    ds_read_b128 v[132:135], v89 offset:4096
    ds_read_b128 v[136:139], v89 offset:4352
    ds_read_b128 v[140:143], v89 offset:4608
    ds_read_b128 v[144:147], v89 offset:4864
    s_waitcnt lgkmcnt(2)
    v_pk_add_f32 v[132:133], v[132:133], v[136:137]
    v_pk_add_f32 v[134:135], v[134:135], v[138:139]
    s_waitcnt lgkmcnt(0)
    v_pk_add_f32 v[140:141], v[140:141], v[144:145]
    v_pk_add_f32 v[142:143], v[142:143], v[146:147]
    v_pk_add_f32 v[132:133], v[132:133], v[140:141]
    v_pk_add_f32 v[134:135], v[134:135], v[142:143]
    s_nop 0
    v_permlane16_swap_b32 v132, v133
    v_permlane16_swap_b32 v134, v135
    v_add_f32 v132, v132, v133
    v_add_f32 v134, v134, v135
    s_nop 1
    v_permlane32_swap_b32 v132, v134
    v_add_f32 v132, v132, v134
    v_cvt_pk_bf16_f32 v132, v132, v132
    v_and_b32 v132, 0xffff0000, v132
    v_and_or_b32 v132, v132, s56, v5
    buffer_store_dword v132, v172, s[44:47], 0 offen
    buffer_store_dword v132, v172, s[44:47], s49 offen sc1
    s_endpgm
L_roleA:
    s_mov_b32 s49, 1048576
    s_mov_b32 s50, 0x05040100
    s_mov_b32 s51, 0x07060302
    s_mov_b32 s52, 0xff00ff00
    s_mov_b32 s53, 0xff00ff00
    s_mov_b32 s54, 0x0c0c0400
    s_mov_b32 s55, 0x04000c0c
    s_mov_b32 s56, 0xffffff00
    s_mov_b32 s57, 0
    s_mov_b32 s63, 255
    s_mov_b32 s84, 0x07060500
    s_mov_b32 s85, 0x07060501
    s_mov_b32 s86, 0x07060502
    s_mov_b32 s87, 0x07060503
    s_lshl_b32 s7, s3, 13
    s_add_u32 s7, s7, 32768
    v_xor_b32 v13, v3, v2
    v_lshlrev_b32 v14, 8, v2
    v_add_u32 v14, s7, v14
    v_lshlrev_b32 v15, 8, v3
    v_add_u32 v15, s7, v15
    v_xor_b32 v220, 0, v13
    v_lshl_add_u32 v234, v220, 4, v14
    v_lshl_add_u32 v238, v220, 4, v15
    v_xor_b32 v220, 4, v13
    v_lshl_add_u32 v235, v220, 4, v14
    v_lshl_add_u32 v239, v220, 4, v15
    v_xor_b32 v220, 8, v13
    v_lshl_add_u32 v236, v220, 4, v14
    v_lshl_add_u32 v240, v220, 4, v15
    v_xor_b32 v220, 12, v13
    v_lshl_add_u32 v237, v220, 4, v14
    v_lshl_add_u32 v241, v220, 4, v15
    v_lshlrev_b32 v220, 11, v2
    v_lshl_add_u32 v220, v3, 4, v220
    s_lshl_b32 s6, s3, 9
    s_add_u32 s6, s6, s48
    s_add_u32 s6, s6, 32768
    v_add_u32 v220, s6, v220
    v_lshl_add_u32 v223, v3, 2, v2
    v_lshlrev_b32 v223, 1, v223
    s_mul_i32 s6, s3, 320
    v_add_u32 v223, s6, v223
    v_and_b32 v224, 3, v3
    v_mul_u32_u24 v224, 320, v224
    v_lshl_add_u32 v224, v2, 4, v224
    v_lshrrev_b32 v13, 2, v3
    v_mul_u32_u24 v226, 320, v13
    v_and_b32 v13, 3, v3
    v_lshl_add_u32 v14, v2, 2, v13
    v_lshl_add_u32 v226, v14, 4, v226
    s_mul_i32 s6, s3, 2592
    v_add_u32 v226, s6, v226
    v_lshlrev_b32 v227, 5, v13
    v_lshl_add_u32 v227, v2, 7, v227
    s_lshl_b32 s6, s3, 2
    v_add_u32 v227, s6, v227
    v_mul_u32_u24 v228, 5184, v2
    v_mul_u32_u24 v14, 320, v8
    v_add_u32 v228, v228, v14
    v_lshl_add_u32 v228, v7, 6, v228
    s_and_b32 s6, s3, 1
    s_lshl_b32 s6, s6, 7
    s_lshr_b32 s7, s3, 1
    s_lshl_b32 s7, s7, 4
    s_add_u32 s6, s6, s7
    v_add_u32 v228, s6, v228
    s_lshl_b32 s7, s7, 1
    v_mov_b32 v229, s7
    v_lshl_add_u32 v230, v2, 3, v229
    s_lshl_b32 s6, s8, 11
    s_lshl_b32 s7, s3, 8
    s_add_u32 s6, s6, s7
    s_add_u32 s6, s6, s48
    v_lshlrev_b32 v231, 2, v2
    v_lshl_add_u32 v231, v3, 4, v231
    v_add_u32 v231, s6, v231
    s_lshl_b32 s9, s4, 2
    s_add_u32 s9, s9, s8
    s_lshl_b32 s6, s9, 1
    s_lshr_b32 s7, s3, 2
    s_add_u32 s14, s6, s7
    s_lshl_b32 s6, s14, 15
    s_and_b32 s7, s3, 3
    s_lshl_b32 s7, s7, 8
    s_add_u32 s6, s6, s7
    s_add_u32 s6, s6, 4096
    v_lshlrev_b32 v225, 13, v2
    v_lshl_add_u32 v225, v3, 4, v225
    v_add_u32 v225, s6, v225
    s_cmp_lt_u32 s8, 4
    s_cselect_b32 s15, 1, 0
    s_cmp_eq_u32 s4, 7
    s_cselect_b32 s15, 0, s15
    s_cmp_lg_u32 s8, 11
    s_cselect_b32 s6, 4, 4
    s_cselect_b32 s7, 9, 1
    s_cmp_lt_u32 s8, 8
    s_cselect_b32 s6, 7, s6
    s_cselect_b32 s7, 15, s7
    s_cmp_lt_u32 s8, 4
    s_cselect_b32 s6, 7, s6
    s_cselect_b32 s7, 15, s7
    s_cmp_eq_u32 s3, s6
    s_cselect_b32 s62, s7, 99
    s_lshl_b32 s6, s8, 4
    s_add_u32 s6, s6, s48
    s_add_u32 s6, s6, 46080
    v_lshlrev_b32 v232, 2, v2
    v_add_u32 v232, s6, v232
    s_waitcnt vmcnt(7)
    global_load_dwordx4 v[48:51], v12, s[20:21] offset:-4096 nt
    v_and_b32 v5, 0x7f7f7f7f, v4
    v_add_u32 v5, 0x4f2b1d35, v5
    v_and_b32 v4, 0x80808080, v4
    v_xor_b32 v4, v4, v5
    v_lshlrev_b32 v5, 3, v2
    v_lshrrev_b32 v5, v5, v4
    v_and_b32 v5, 0xff, v5
    ds_write_b128 v234, v[16:19] offset:0
    s_waitcnt vmcnt(7)
    global_load_dwordx4 v[52:55], v12, s[20:21] offset:-3840 nt
    s_cmp_lg_u32 s62, 1
    s_cbranch_scc1 L_nogo_8
    v_mov_b32 v14, 0
    s_mov_b32 exec_lo, 0x00010001
    s_mov_b32 exec_hi, 0x00010001
    v_and_or_b32 v14, v14, s56, v5
    buffer_store_dword v14, v232, s[44:47], 0 offen
    buffer_store_dword v14, v232, s[44:47], s49 offen sc1
    s_mov_b64 exec, -1
L_nogo_8:
    ds_write_b128 v235, v[20:23] offset:1024
    s_waitcnt vmcnt(7)
    global_load_dwordx4 v[56:59], v12, s[20:21] offset:-3584 nt
    ds_write_b128 v236, v[24:27] offset:2048
    s_waitcnt vmcnt(7)
    global_load_dwordx4 v[60:63], v12, s[20:21] offset:-3328 nt
    ds_write_b128 v237, v[28:31] offset:3072
    s_waitcnt vmcnt(7)
    global_load_dwordx4 v[64:67], v12, s[20:21] offset:0 nt
    ds_write_b128 v234, v[32:35] offset:4096
    s_waitcnt vmcnt(7)
    global_load_dwordx4 v[68:71], v12, s[20:21] offset:256 nt
    ds_write_b128 v235, v[36:39] offset:5120
    s_waitcnt vmcnt(7)
    global_load_dwordx4 v[72:75], v12, s[20:21] offset:512 nt
    ds_write_b128 v236, v[40:43] offset:6144
    s_waitcnt vmcnt(7)
    global_load_dwordx4 v[76:79], v12, s[20:21] offset:768 nt
    ds_write_b128 v237, v[44:47] offset:7168
    s_waitcnt lgkmcnt(0)
    ds_read_b128 v[88:91], v238 offset:0
    ds_read_b128 v[92:95], v239 offset:0
    ds_read_b128 v[96:99], v240 offset:0
    ds_read_b128 v[100:103], v241 offset:0
    ds_read_b128 v[104:107], v238 offset:4096
    ds_read_b128 v[108:111], v239 offset:4096
    ds_read_b128 v[112:115], v240 offset:4096
    ds_read_b128 v[116:119], v241 offset:4096
    s_waitcnt vmcnt(7)
    s_waitcnt vmcnt(6)
    s_cmp_lg_u32 s62, 9
    s_cbranch_scc1 L_nogo_9
    v_mov_b32 v14, 0
    s_mov_b32 exec_lo, 0x00010001
    s_mov_b32 exec_hi, 0x00010001
    v_and_or_b32 v14, v14, s56, v5
    buffer_store_dword v14, v232, s[44:47], 0 offen
    buffer_store_dword v14, v232, s[44:47], s49 offen sc1
    s_mov_b64 exec, -1
L_nogo_9:
    v_perm_b32 v120, v52, v48, s50
    v_perm_b32 v124, v52, v48, s51
    v_perm_b32 v128, v53, v49, s50
    v_perm_b32 v132, v53, v49, s51
    v_perm_b32 v136, v54, v50, s50
    v_perm_b32 v140, v54, v50, s51
    v_perm_b32 v144, v55, v51, s50
    v_perm_b32 v148, v55, v51, s51
    s_waitcnt vmcnt(5)
    s_waitcnt vmcnt(4)
    v_perm_b32 v121, v60, v56, s50
    v_perm_b32 v125, v60, v56, s51
    v_perm_b32 v129, v61, v57, s50
    v_perm_b32 v133, v61, v57, s51
    v_perm_b32 v137, v62, v58, s50
    v_perm_b32 v141, v62, v58, s51
    v_perm_b32 v145, v63, v59, s50
    v_perm_b32 v149, v63, v59, s51
    s_waitcnt vmcnt(3)
    s_waitcnt vmcnt(2)
    v_perm_b32 v122, v68, v64, s50
    v_perm_b32 v126, v68, v64, s51
    v_perm_b32 v130, v69, v65, s50
    v_perm_b32 v134, v69, v65, s51
    v_perm_b32 v138, v70, v66, s50
    v_perm_b32 v142, v70, v66, s51
    v_perm_b32 v146, v71, v67, s50
    v_perm_b32 v150, v71, v67, s51
    s_waitcnt vmcnt(1)
    s_waitcnt vmcnt(0)
    s_cmp_lg_u32 s62, 15
    s_cbranch_scc1 L_nogo_10
    v_mov_b32 v14, 0
    s_mov_b32 exec_lo, 0x00010001
    s_mov_b32 exec_hi, 0x00010001
    v_and_or_b32 v14, v14, s56, v5
    buffer_store_dword v14, v232, s[44:47], 0 offen
    buffer_store_dword v14, v232, s[44:47], s49 offen sc1
    s_mov_b64 exec, -1
L_nogo_10:
    v_perm_b32 v123, v76, v72, s50
    v_perm_b32 v127, v76, v72, s51
    v_perm_b32 v131, v77, v73, s50
    v_perm_b32 v135, v77, v73, s51
    v_perm_b32 v139, v78, v74, s50
    v_perm_b32 v143, v78, v74, s51
    v_perm_b32 v147, v79, v75, s50
    v_perm_b32 v151, v79, v75, s51
    s_cmp_ge_u32 s3, 4
    s_cbranch_scc1 L_q_skip
    s_mov_b64 exec, 1
    global_load_dword v216, v6, s[32:33]
    s_mov_b64 exec, -1
    s_branch L_poll_11_p
L_poll_11_s:
    s_mov_b32 s63, 3
    s_waitcnt vmcnt(0)
    buffer_load_dwordx4 v[16:19], v220, s[44:47], s49 offen offset:0 sc1
    buffer_load_dwordx4 v[20:23], v220, s[44:47], s49 offen offset:256 sc1
    s_waitcnt vmcnt(1)
    v_perm_b32 v13, v17, v16, s54
    v_perm_b32 v14, v19, v18, s55
    v_bitop3_b32 v15, v13, v14, v4 bitop3:0x56
    s_waitcnt vmcnt(0)
    v_perm_b32 v13, v21, v20, s54
    v_perm_b32 v14, v23, v22, s55
    v_bitop3_b32 v13, v13, v14, v4 bitop3:0x56
    v_or_b32 v15, v15, v13
    v_cmp_ne_u32 vcc, 0, v15
    s_mov_b64 exec, vcc
    s_cbranch_vccz L_poll_11_d
L_poll_11_p:
L_poll_11:
    buffer_load_dwordx4 v[16:19], v220, s[44:47], 0 offen offset:0 sc1
    buffer_load_dwordx4 v[20:23], v220, s[44:47], 0 offen offset:256 sc1
    s_add_u32 s57, s57, 1
    s_cmp_gt_u32 s57, 200000
    s_cbranch_scc1 L_end
    s_and_b32 s59, s57, s63
    s_cbranch_scc0 L_poll_11_s
    s_waitcnt vmcnt(1)
    v_perm_b32 v13, v17, v16, s54
    v_perm_b32 v14, v19, v18, s55
    v_bitop3_b32 v15, v13, v14, v4 bitop3:0x56
    s_waitcnt vmcnt(0)
    v_perm_b32 v13, v21, v20, s54
    v_perm_b32 v14, v23, v22, s55
    v_bitop3_b32 v13, v13, v14, v4 bitop3:0x56
    v_or_b32 v15, v15, v13
    v_cmp_ne_u32 vcc, 0, v15
    s_mov_b64 exec, vcc
    s_cbranch_vccnz L_poll_11
L_poll_11_d:
    s_mov_b64 exec, -1
    v_and_b32 v184, s56, v16
    v_and_b32 v185, s56, v17
    v_and_b32 v186, s56, v18
    v_and_b32 v187, s56, v19
    v_and_b32 v188, s56, v20
    v_and_b32 v189, s56, v21
    v_and_b32 v190, s56, v22
    v_and_b32 v191, s56, v23
    v_permlane16_swap_b32 v184, v185
    v_permlane16_swap_b32 v186, v187
    v_add_f32 v184, v184, v185
    v_add_f32 v186, v186, v187
    s_nop 1
    v_permlane32_swap_b32 v184, v186
    v_add_f32 v184, v184, v186
    v_permlane16_swap_b32 v188, v189
    v_permlane16_swap_b32 v190, v191
    v_add_f32 v188, v188, v189
    v_add_f32 v190, v190, v191
    s_nop 1
    v_permlane32_swap_b32 v188, v190
    v_add_f32 v188, v188, v190
    v_cvt_pk_bf16_f32 v184, v184, v188
    ds_write_b16 v223, v184 offset:22528
    ds_write_b16_d16_hi v223, v184 offset:22656
L_q_skip:
    s_waitcnt lgkmcnt(0)
    s_barrier
    ds_read_b128 v[188:191], v224 offset:22528
    ds_read_b128 v[192:195], v224 offset:22592
    ds_read_b128 v[196:199], v224 offset:22656
    ds_read_b128 v[200:203], v224 offset:22720
    s_waitcnt lgkmcnt(3)
    v_mfma_f32_16x16x32_bf16 v[204:207], v[88:91], v[188:191], 0
    v_mfma_f32_16x16x32_bf16 v[208:211], v[104:107], v[188:191], 0
    s_waitcnt lgkmcnt(2)
    v_mfma_f32_16x16x32_bf16 v[204:207], v[92:95], v[192:195], v[204:207]
    v_mfma_f32_16x16x32_bf16 v[208:211], v[108:111], v[192:195], v[208:211]
    s_waitcnt lgkmcnt(1)
    v_mfma_f32_16x16x32_bf16 v[204:207], v[96:99], v[196:199], v[204:207]
    v_mfma_f32_16x16x32_bf16 v[208:211], v[112:115], v[196:199], v[208:211]
    s_waitcnt lgkmcnt(0)
    v_mfma_f32_16x16x32_bf16 v[204:207], v[100:103], v[200:203], v[204:207]
    v_mfma_f32_16x16x32_bf16 v[208:211], v[116:119], v[200:203], v[208:211]
    s_nop 6
    v_mov_b32_dpp v204, v206 quad_perm:[0,1,2,3] row_mask:0xf bank_mask:2
    v_mov_b32_dpp v205, v207 quad_perm:[0,1,2,3] row_mask:0xf bank_mask:2
    s_nop 0
    v_mov_b32_dpp v204, v208 quad_perm:[0,1,2,3] row_mask:0xf bank_mask:4
    v_mov_b32_dpp v205, v209 quad_perm:[0,1,2,3] row_mask:0xf bank_mask:4
    s_nop 0
    v_mov_b32_dpp v204, v210 quad_perm:[0,1,2,3] row_mask:0xf bank_mask:8
    v_mov_b32_dpp v205, v211 quad_perm:[0,1,2,3] row_mask:0xf bank_mask:8
    v_cvt_pk_bf16_f32 v216, v204, v205
    v_lshlrev_b32 v204, 16, v216
    v_and_b32 v205, 0xffff0000, v216
    v_mul_f32 v204, 0x3db504f3, v204
    v_mul_f32 v205, 0x3db504f3, v205
    v_cvt_pk_bf16_f32 v216, v204, v205
    v_lshlrev_b32 v204, 16, v216
    v_and_b32 v205, 0xffff0000, v216
    v_max_f32 v221, v204, v205
    s_nop 1
    v_max_f32_dpp v221, v221, v221 row_ror:8 row_mask:0xf bank_mask:0xf
    s_nop 1
    v_max_f32_dpp v221, v221, v221 row_ror:4 row_mask:0xf bank_mask:0xf
    v_mov_b32 v13, v221
    s_nop 1
    v_permlane16_swap_b32 v221, v13
    v_max_f32 v221, v221, v13
    v_mov_b32 v13, v221
    s_nop 1
    v_permlane32_swap_b32 v221, v13
    v_max_f32 v221, v221, v13
    v_sub_f32 v204, v204, v221
    v_sub_f32 v205, v205, v221
    v_mul_f32 v204, 1069066811, v204
    v_mul_f32 v205, 1069066811, v205
    v_exp_f32 v204, v204
    v_exp_f32 v205, v205
    s_nop 0
    v_cvt_pk_bf16_f32 v212, v204, v205
    v_add_f32 v222, v204, v205
    s_nop 0
    v_mov_b32_dpp v213, v212 row_shl:4 row_mask:0xf bank_mask:0xf bound_ctrl:0
    v_mov_b32_dpp v214, v212 row_shl:8 row_mask:0xf bank_mask:0xf bound_ctrl:0
    v_mov_b32_dpp v215, v212 row_shl:12 row_mask:0xf bank_mask:0xf bound_ctrl:0
    s_nop 1
    v_mfma_f32_16x16x32_bf16 v[152:155], v[120:123], v[212:215], 0
    v_mfma_f32_16x16x32_bf16 v[156:159], v[124:127], v[212:215], 0
    v_mfma_f32_16x16x32_bf16 v[160:163], v[128:131], v[212:215], 0
    v_mfma_f32_16x16x32_bf16 v[164:167], v[132:135], v[212:215], 0
    v_mfma_f32_16x16x32_bf16 v[168:171], v[136:139], v[212:215], 0
    v_mfma_f32_16x16x32_bf16 v[172:175], v[140:143], v[212:215], 0
    v_mfma_f32_16x16x32_bf16 v[176:179], v[144:147], v[212:215], 0
    v_mfma_f32_16x16x32_bf16 v[180:183], v[148:151], v[212:215], 0
    v_add_f32_dpp v222, v222, v222 row_ror:8 row_mask:0xf bank_mask:0xf
    s_nop 1
    v_add_f32_dpp v222, v222, v222 row_ror:4 row_mask:0xf bank_mask:0xf
    v_mov_b32 v13, v222
    s_nop 1
    v_permlane16_swap_b32 v222, v13
    v_add_f32 v222, v222, v13
    v_mov_b32 v13, v222
    s_nop 1
    v_permlane32_swap_b32 v222, v13
    v_add_f32 v222, v222, v13
    v_mov_b32_dpp v152, v156 row_shr:4 row_mask:0xf bank_mask:2
    v_mov_b32_dpp v153, v157 row_shr:4 row_mask:0xf bank_mask:2
    v_mov_b32_dpp v154, v158 row_shr:4 row_mask:0xf bank_mask:2
    v_mov_b32_dpp v155, v159 row_shr:4 row_mask:0xf bank_mask:2
    v_mov_b32_dpp v152, v160 row_shr:8 row_mask:0xf bank_mask:4
    v_mov_b32_dpp v153, v161 row_shr:8 row_mask:0xf bank_mask:4
    v_mov_b32_dpp v154, v162 row_shr:8 row_mask:0xf bank_mask:4
    v_mov_b32_dpp v155, v163 row_shr:8 row_mask:0xf bank_mask:4
    v_mov_b32_dpp v152, v164 row_shr:12 row_mask:0xf bank_mask:8
    v_mov_b32_dpp v153, v165 row_shr:12 row_mask:0xf bank_mask:8
    v_mov_b32_dpp v154, v166 row_shr:12 row_mask:0xf bank_mask:8
    v_mov_b32_dpp v155, v167 row_shr:12 row_mask:0xf bank_mask:8
    ds_write_b128 v226, v[152:155] offset:0
    v_mov_b32_dpp v168, v172 row_shr:4 row_mask:0xf bank_mask:2
    v_mov_b32_dpp v169, v173 row_shr:4 row_mask:0xf bank_mask:2
    v_mov_b32_dpp v170, v174 row_shr:4 row_mask:0xf bank_mask:2
    v_mov_b32_dpp v171, v175 row_shr:4 row_mask:0xf bank_mask:2
    v_mov_b32_dpp v168, v176 row_shr:8 row_mask:0xf bank_mask:4
    v_mov_b32_dpp v169, v177 row_shr:8 row_mask:0xf bank_mask:4
    v_mov_b32_dpp v170, v178 row_shr:8 row_mask:0xf bank_mask:4
    v_mov_b32_dpp v171, v179 row_shr:8 row_mask:0xf bank_mask:4
    v_mov_b32_dpp v168, v180 row_shr:12 row_mask:0xf bank_mask:8
    v_mov_b32_dpp v169, v181 row_shr:12 row_mask:0xf bank_mask:8
    v_mov_b32_dpp v170, v182 row_shr:12 row_mask:0xf bank_mask:8
    v_mov_b32_dpp v171, v183 row_shr:12 row_mask:0xf bank_mask:8
    ds_write_b128 v226, v[168:171] offset:1280
    s_mov_b32 vcc_lo, 0xffff0000
    s_mov_b32 vcc_hi, 0
    v_cndmask_b32 v221, v221, v222, vcc
    s_mov_b64 exec, 0x000f000f
    ds_write_b32 v227, v221 offset:20992
    s_mov_b64 exec, -1
    s_waitcnt lgkmcnt(0)
    s_barrier
    ds_read_b128 v[88:91], v229 offset:20992
    ds_read_b128 v[92:95], v229 offset:21008
    ds_read_b64 v[96:97], v230 offset:20992
    ds_read_b64 v[98:99], v230 offset:21120
    ds_read_b128 v[100:103], v228 offset:0
    ds_read_b128 v[104:107], v228 offset:2592
    s_waitcnt lgkmcnt(3)
    v_max3_f32 v221, v88, v89, v90
    v_max3_f32 v13, v91, v92, v93
    v_max3_f32 v221, v221, v94, v95
    v_max_f32 v221, v221, v13
    v_sub_f32 v96, v96, v221
    v_sub_f32 v97, v97, v221
    v_mul_f32 v96, 1069066811, v96
    v_mul_f32 v97, 1069066811, v97
    v_exp_f32 v96, v96
    v_exp_f32 v97, v97
    s_waitcnt lgkmcnt(0)
    v_mul_f32 v100, v96, v100
    v_mul_f32 v101, v96, v101
    v_mul_f32 v102, v96, v102
    v_mul_f32 v103, v96, v103
    v_fmac_f32 v100, v97, v104
    v_fmac_f32 v101, v97, v105
    v_fmac_f32 v102, v97, v106
    v_fmac_f32 v103, v97, v107
    v_permlane16_swap_b32 v100, v101
    s_nop 0
    v_permlane16_swap_b32 v102, v103
    v_add_f32 v100, v100, v101
    v_add_f32 v102, v102, v103
    s_nop 1
    v_permlane32_swap_b32 v100, v102
    v_add_f32 v100, v100, v102
    v_and_or_b32 v100, v100, s56, v5
    buffer_store_dword v100, v231, s[44:47], 0 offen
    buffer_store_dword v100, v231, s[44:47], s49 offen sc1
    s_bcnt1_i32_b32 s6, s3
    s_bitcmp1_b32 s6, 0
    s_cbranch_scc1 L_noml
    v_mul_f32 v222, v96, v98
    v_fmac_f32 v222, v97, v99
    v_mov_b32 v13, v222
    s_nop 1
    v_permlane16_swap_b32 v222, v13
    v_add_f32 v222, v222, v13
    v_mov_b32 v13, v222
    s_nop 1
    v_permlane32_swap_b32 v222, v13
    v_add_f32 v222, v222, v13
    s_mov_b32 vcc_lo, 0xffff0000
    s_mov_b32 vcc_hi, 0xffff0000
    v_cndmask_b32 v221, v221, v222, vcc
    s_lshr_b32 s6, s3, 1
    s_lshl_b32 s6, s6, 4
    s_add_u32 s6, s6, s8
    s_lshl_b32 s6, s6, 4
    s_add_u32 s6, s6, s48
    s_add_u32 s6, s6, 45056
    v_lshlrev_b32 v13, 2, v2
    v_add_u32 v13, s6, v13
    s_mov_b32 exec_lo, 0x00010001
    s_mov_b32 exec_hi, 0x00010001
    v_and_or_b32 v221, v221, s56, v5
    buffer_store_dword v221, v13, s[44:47], 0 offen
    buffer_store_dword v221, v13, s[44:47], s49 offen sc1
    s_mov_b64 exec, -1
L_noml:
    s_cmp_lg_u32 s3, 1
    s_cbranch_scc1 L_nocomb
    v_lshrrev_b32 v13, 3, v1
    v_lshlrev_b32 v220, 11, v13
    v_lshl_add_u32 v220, v8, 4, v220
    s_lshl_b32 s6, s8, 7
    s_add_u32 s6, s6, s48
    v_add_u32 v220, s6, v220
    v_add_u32 v221, 0x4000, v220
    v_lshl_add_u32 v222, v2, 1, v3
    v_and_b32 v222, 15, v222
    v_lshlrev_b32 v222, 4, v222
    s_lshr_b32 s6, s8, 2
    s_lshl_b32 s6, s6, 8
    s_add_u32 s6, s6, s48
    s_add_u32 s6, s6, 45056
    v_add_u32 v222, s6, v222
    s_lshl_b32 s6, s8, 7
    s_add_u32 s6, s6, s48
    s_add_u32 s6, s6, 40960
    v_lshlrev_b32 v223, 2, v2
    v_lshl_add_u32 v223, v8, 4, v223
    v_add_u32 v223, s6, v223
    s_nop 2
    s_branch L_poll_12_p
L_poll_12_s:
    s_mov_b32 s63, 3
    s_waitcnt vmcnt(0)
    buffer_load_dwordx4 v[24:27], v222, s[44:47], s49 offen offset:0 sc1
    buffer_load_dwordx4 v[28:31], v220, s[44:47], s49 offen offset:0 sc1
    buffer_load_dwordx4 v[32:35], v221, s[44:47], s49 offen offset:0 sc1
    s_waitcnt vmcnt(2)
    v_perm_b32 v13, v25, v24, s54
    v_perm_b32 v14, v27, v26, s55
    v_bitop3_b32 v15, v13, v14, v4 bitop3:0x56
    s_waitcnt vmcnt(1)
    v_perm_b32 v13, v29, v28, s54
    v_perm_b32 v14, v31, v30, s55
    v_bitop3_b32 v13, v13, v14, v4 bitop3:0x56
    v_or_b32 v15, v15, v13
    s_waitcnt vmcnt(0)
    v_perm_b32 v13, v33, v32, s54
    v_perm_b32 v14, v35, v34, s55
    v_bitop3_b32 v13, v13, v14, v4 bitop3:0x56
    v_or_b32 v15, v15, v13
    v_cmp_ne_u32 vcc, 0, v15
    s_mov_b64 exec, vcc
    s_cbranch_vccz L_poll_12_d
L_poll_12_p:
L_poll_12:
    buffer_load_dwordx4 v[24:27], v222, s[44:47], 0 offen offset:0 sc1
    buffer_load_dwordx4 v[28:31], v220, s[44:47], 0 offen offset:0 sc1
    buffer_load_dwordx4 v[32:35], v221, s[44:47], 0 offen offset:0 sc1
    s_add_u32 s57, s57, 1
    s_cmp_gt_u32 s57, 200000
    s_cbranch_scc1 L_end
    s_and_b32 s59, s57, s63
    s_cbranch_scc0 L_poll_12_s
    s_waitcnt vmcnt(2)
    v_perm_b32 v13, v25, v24, s54
    v_perm_b32 v14, v27, v26, s55
    v_bitop3_b32 v15, v13, v14, v4 bitop3:0x56
    s_waitcnt vmcnt(1)
    v_perm_b32 v13, v29, v28, s54
    v_perm_b32 v14, v31, v30, s55
    v_bitop3_b32 v13, v13, v14, v4 bitop3:0x56
    v_or_b32 v15, v15, v13
    s_waitcnt vmcnt(0)
    v_perm_b32 v13, v33, v32, s54
    v_perm_b32 v14, v35, v34, s55
    v_bitop3_b32 v13, v13, v14, v4 bitop3:0x56
    v_or_b32 v15, v15, v13
    v_cmp_ne_u32 vcc, 0, v15
    s_mov_b64 exec, vcc
    s_cbranch_vccnz L_poll_12
L_poll_12_d:
    s_mov_b64 exec, -1
    v_and_b32 v196, 0xffff0000, v24
    s_nop 1
    v_max_f32_dpp v13, v196, v196 row_ror:8 row_mask:0xf bank_mask:0xf
    s_nop 1
    v_max_f32_dpp v13, v13, v13 row_ror:4 row_mask:0xf bank_mask:0xf
    s_nop 1
    v_max_f32_dpp v13, v13, v13 row_ror:2 row_mask:0xf bank_mask:0xf
    s_nop 1
    v_max_f32_dpp v13, v13, v13 row_ror:1 row_mask:0xf bank_mask:0xf
    v_sub_f32 v196, v196, v13
    v_mul_f32 v196, 1069066811, v196
    v_exp_f32 v196, v196
    s_nop 0
    v_mul_f32 v14, v196, v25
    v_mov_b32_dpp v204, v196 row_newbcast:0 row_mask:0xf bank_mask:0x3
    v_mov_b32_dpp v205, v196 row_newbcast:8 row_mask:0xf bank_mask:0x3
    v_add_f32_dpp v14, v14, v14 row_ror:8 row_mask:0xf bank_mask:0xf
    v_mov_b32_dpp v204, v196 row_newbcast:1 row_mask:0xf bank_mask:0xc
    v_mov_b32_dpp v205, v196 row_newbcast:9 row_mask:0xf bank_mask:0xc
    v_add_f32_dpp v14, v14, v14 row_ror:4 row_mask:0xf bank_mask:0xf
    v_mul_f32 v188, v204, v28
    v_mul_f32 v189, v204, v29
    v_mul_f32 v190, v204, v30
    v_mul_f32 v191, v204, v31
    v_add_f32_dpp v14, v14, v14 row_ror:2 row_mask:0xf bank_mask:0xf
    v_fmac_f32 v188, v205, v32
    v_fmac_f32 v189, v205, v33
    v_fmac_f32 v190, v205, v34
    v_fmac_f32 v191, v205, v35
    v_add_f32_dpp v14, v14, v14 row_ror:1 row_mask:0xf bank_mask:0xf
    v_rcp_f32 v14, v14
    v_permlane16_swap_b32 v188, v189
    v_permlane16_swap_b32 v190, v191
    v_add_f32 v188, v188, v189
    v_add_f32 v190, v190, v191
    s_nop 1
    v_permlane32_swap_b32 v188, v190
    v_add_f32 v188, v188, v190
    s_nop 1
    v_add_f32_dpp v188, v188, v188 row_ror:8 row_mask:0xf bank_mask:0xf
    v_mul_f32 v188, v188, v14
    v_cvt_pk_bf16_f32 v188, v188, v188
    v_and_b32 v188, 0xffff0000, v188
    s_mov_b32 exec_lo, 0x00ff00ff
    s_mov_b32 exec_hi, 0x00ff00ff
    v_and_or_b32 v188, v188, s56, v5
    buffer_store_dword v188, v223, s[44:47], 0 offen
    buffer_store_dword v188, v223, s[44:47], s49 offen sc1
    s_mov_b64 exec, -1
L_nocomb:
    s_cmp_eq_u32 s15, 0
    s_cbranch_scc1 L_fin
    s_waitcnt vmcnt(0)
    s_barrier
    global_load_dwordx4 v[16:19], v225, s[32:33] offset:-4096 nt
    global_load_dwordx4 v[20:23], v225, s[32:33] offset:-3072 nt
    global_load_dwordx4 v[24:27], v225, s[32:33] offset:-2048 nt
    global_load_dwordx4 v[28:31], v225, s[32:33] offset:-1024 nt
    global_load_dwordx4 v[32:35], v225, s[32:33] offset:0 nt
    global_load_dwordx4 v[36:39], v225, s[32:33] offset:1024 nt
    global_load_dwordx4 v[40:43], v225, s[32:33] offset:2048 nt
    global_load_dwordx4 v[44:47], v225, s[32:33] offset:3072 nt
    s_lshl_b32 s6, s8, 9
    s_lshr_b32 s7, s3, 2
    s_lshl_b32 s7, s7, 7
    s_add_u32 s6, s6, s7
    s_add_u32 s6, s6, s48
    s_add_u32 s6, s6, 43008
    v_lshlrev_b32 v220, 8, v7
    v_lshl_add_u32 v220, v8, 4, v220
    v_add_u32 v220, s6, v220
    s_lshl_b32 s6, s3, 6
    v_lshl_add_u32 v234, v3, 2, v2
    v_lshlrev_b32 v234, 1, v234
    v_add_u32 v234, s6, v234
    v_lshlrev_b32 v238, 4, v2
    v_add_u32 v238, s6, v238
    s_lshl_b32 s6, s14, 11
    s_and_b32 s7, s3, 3
    s_lshl_b32 s7, s7, 9
    s_add_u32 s6, s6, s7
    s_add_u32 s6, s6, 65536
    v_lshlrev_b32 v221, 5, v3
    v_lshl_add_u32 v221, v2, 4, v221
    v_add_u32 v221, s6, v221
    s_waitcnt vmcnt(0)
    v_perm_b32 v48, v20, v16, s50
    v_perm_b32 v52, v20, v16, s51
    v_perm_b32 v56, v21, v17, s50
    v_perm_b32 v60, v21, v17, s51
    v_perm_b32 v64, v22, v18, s50
    v_perm_b32 v68, v22, v18, s51
    v_perm_b32 v72, v23, v19, s50
    v_perm_b32 v76, v23, v19, s51
    v_perm_b32 v49, v28, v24, s50
    v_perm_b32 v53, v28, v24, s51
    v_perm_b32 v57, v29, v25, s50
    v_perm_b32 v61, v29, v25, s51
    v_perm_b32 v65, v30, v26, s50
    v_perm_b32 v69, v30, v26, s51
    v_perm_b32 v73, v31, v27, s50
    v_perm_b32 v77, v31, v27, s51
    v_perm_b32 v50, v36, v32, s50
    v_perm_b32 v54, v36, v32, s51
    v_perm_b32 v58, v37, v33, s50
    v_perm_b32 v62, v37, v33, s51
    v_perm_b32 v66, v38, v34, s50
    v_perm_b32 v70, v38, v34, s51
    v_perm_b32 v74, v39, v35, s50
    v_perm_b32 v78, v39, v35, s51
    v_perm_b32 v51, v44, v40, s50
    v_perm_b32 v55, v44, v40, s51
    v_perm_b32 v59, v45, v41, s50
    v_perm_b32 v63, v45, v41, s51
    v_perm_b32 v67, v46, v42, s50
    v_perm_b32 v71, v46, v42, s51
    v_perm_b32 v75, v47, v43, s50
    v_perm_b32 v79, v47, v43, s51
    s_nop 2
    s_branch L_poll_13_p
L_poll_13_s:
    s_mov_b32 s63, 3
    s_waitcnt vmcnt(0)
    buffer_load_dwordx4 v[188:191], v220, s[44:47], s49 offen offset:0 sc1
    s_waitcnt vmcnt(0)
    v_perm_b32 v13, v189, v188, s54
    v_perm_b32 v14, v191, v190, s55
    v_bitop3_b32 v15, v13, v14, v4 bitop3:0x56
    v_cmp_ne_u32 vcc, 0, v15
    s_mov_b64 exec, vcc
    s_cbranch_vccz L_poll_13_d
L_poll_13_p:
L_poll_13:
    buffer_load_dwordx4 v[188:191], v220, s[44:47], 0 offen offset:0 sc1
    s_add_u32 s57, s57, 1
    s_cmp_gt_u32 s57, 200000
    s_cbranch_scc1 L_end
    s_and_b32 s59, s57, s63
    s_cbranch_scc0 L_poll_13_s
    s_waitcnt vmcnt(0)
    v_perm_b32 v13, v189, v188, s54
    v_perm_b32 v14, v191, v190, s55
    v_bitop3_b32 v15, v13, v14, v4 bitop3:0x56
    v_cmp_ne_u32 vcc, 0, v15
    s_mov_b64 exec, vcc
    s_cbranch_vccnz L_poll_13
L_poll_13_d:
    s_mov_b64 exec, -1
    s_mov_b32 vcc_lo, 0xffff0000
    s_mov_b32 vcc_hi, 0xffff0000
    v_cndmask_b32 v184, v188, v189, vcc
    v_cndmask_b32 v185, v190, v191, vcc
    s_mov_b32 vcc_lo, 0
    s_mov_b32 vcc_hi, -1
    v_cndmask_b32 v184, v184, v185, vcc
    v_and_b32 v184, 0xffff0000, v184
    v_mul_f32 v13, v184, v184
    v_mul_f32 v13, 0x3d372713, v13
    v_mov_b32_dpp v14, v184 row_shl:8 row_mask:0xf bank_mask:0xf bound_ctrl:0
    v_add_f32 v13, 1.0, v13
    v_mul_f32 v13, v13, v184
    v_mul_f32 v13, 0xc0135761, v13
    v_exp_f32 v13, v13
    s_nop 0
    v_add_f32 v13, 1.0, v13
    v_rcp_f32 v13, v13
    s_nop 0
    v_mul_f32 v13, v13, v184
    v_cvt_pk_bf16_f32 v13, v13, v13
    v_and_b32 v13, 0xffff0000, v13
    v_mul_f32 v13, v13, v14
    v_cvt_pk_bf16_f32 v13, v13, v13
    s_mov_b32 exec_lo, 0x00ff00ff
    s_mov_b32 exec_hi, 0x00ff00ff
    ds_write_b16 v234, v13 offset:21504
    s_mov_b64 exec, -1
    s_waitcnt lgkmcnt(0)
    ds_read_b128 v[212:215], v238 offset:21504
    s_waitcnt lgkmcnt(0)
    v_mfma_f32_16x16x32_bf16 v[152:155], v[212:215], v[48:51], 0
    v_mfma_f32_16x16x32_bf16 v[156:159], v[212:215], v[52:55], 0
    v_mfma_f32_16x16x32_bf16 v[160:163], v[212:215], v[56:59], 0
    v_mfma_f32_16x16x32_bf16 v[164:167], v[212:215], v[60:63], 0
    v_mfma_f32_16x16x32_bf16 v[168:171], v[212:215], v[64:67], 0
    v_mfma_f32_16x16x32_bf16 v[172:175], v[212:215], v[68:71], 0
    v_mfma_f32_16x16x32_bf16 v[176:179], v[212:215], v[72:75], 0
    v_mfma_f32_16x16x32_bf16 v[180:183], v[212:215], v[76:79], 0
    s_mov_b32 vcc_lo, 0xffff0000
    s_mov_b32 vcc_hi, 0
    s_nop 2
    v_cndmask_b32 v204, v152, v168, vcc
    v_cndmask_b32 v205, v156, v172, vcc
    v_cndmask_b32 v206, v160, v176, vcc
    v_cndmask_b32 v207, v164, v180, vcc
    v_perm_b32 v204, v204, v4, s84
    v_perm_b32 v205, v205, v4, s85
    v_perm_b32 v206, v206, v4, s86
    v_perm_b32 v207, v207, v4, s87
    s_mov_b32 exec_hi, 0
    buffer_store_dwordx4 v[204:207], v221, s[44:47], 0 offen sc1
    s_mov_b64 exec, -1
    s_endpgm
L_fin:
    s_sub_u32 s6, s8, 4
    s_cmp_ge_u32 s6, 2
    s_cbranch_scc1 L_end
    s_cmp_ge_u32 s3, 1
    s_cbranch_scc1 L_end
    s_lshl_b32 s9, s4, 1
    s_add_u32 s9, s9, s6
    s_lshl_b32 s6, s9, 6
    v_lshl_add_u32 v13, v8, 2, v2
    v_lshlrev_b32 v11, 1, v13
    v_add_u32 v11, s6, v11
    global_load_ushort v212, v11, s[16:17]
    global_load_ushort v160, v11, s[38:39]
    s_lshl_b32 s6, s9, 7
    s_add_u32 s7, s6, 8192
    v_lshlrev_b32 v220, 4, v8
    v_add_u32 v221, s7, v220
    v_add_u32 v222, 6144, v221
    v_lshlrev_b32 v204, 5, v1
    v_add_u32 v204, 14336, v204
    s_nop 2
L_poll_14:
    buffer_load_dwordx4 v[48:51], v221, s[44:47], 0 offen offset:0 sc1
    buffer_load_dwordx4 v[52:55], v222, s[44:47], 0 offen offset:0 sc1
    buffer_load_dwordx4 v[120:123], v204, s[44:47], 0 offen offset:0 sc1
    buffer_load_dwordx4 v[124:127], v204, s[44:47], 0 offen offset:16 sc1
    s_add_u32 s57, s57, 1
    s_cmp_gt_u32 s57, 200000
    s_cbranch_scc1 L_end
    s_waitcnt vmcnt(3)
    v_perm_b32 v13, v49, v48, s54
    v_perm_b32 v14, v51, v50, s55
    v_bitop3_b32 v15, v13, v14, v4 bitop3:0x56
    s_waitcnt vmcnt(2)
    v_perm_b32 v13, v53, v52, s54
    v_perm_b32 v14, v55, v54, s55
    v_bitop3_b32 v13, v13, v14, v4 bitop3:0x56
    v_or_b32 v15, v15, v13
    s_waitcnt vmcnt(1)
    v_perm_b32 v13, v121, v120, s54
    v_perm_b32 v14, v123, v122, s55
    v_bitop3_b32 v13, v13, v14, v4 bitop3:0x56
    v_or_b32 v15, v15, v13
    s_waitcnt vmcnt(0)
    v_perm_b32 v13, v125, v124, s54
    v_perm_b32 v14, v127, v126, s55
    v_bitop3_b32 v13, v13, v14, v4 bitop3:0x56
    v_or_b32 v15, v15, v13
    v_cmp_ne_u32 vcc, 0, v15
    s_mov_b64 exec, vcc
    s_cbranch_vccnz L_poll_14
    s_mov_b64 exec, -1
    s_mov_b32 vcc_lo, 4294901760
    s_mov_b32 vcc_hi, 0
    v_cndmask_b32 v48, v48, v49, vcc
    v_cndmask_b32 v52, v52, v53, vcc
    s_mov_b32 vcc_lo, 0
    s_mov_b32 vcc_hi, 65535
    v_cndmask_b32 v48, v48, v50, vcc
    v_cndmask_b32 v52, v52, v54, vcc
    s_mov_b32 vcc_lo, 0
    s_mov_b32 vcc_hi, 4294901760
    v_cndmask_b32 v48, v48, v51, vcc
    v_cndmask_b32 v52, v52, v55, vcc
    v_and_b32 v48, 0xffff0000, v48
    v_and_b32 v52, 0xffff0000, v52
    v_lshlrev_b32 v212, 16, v212
    s_add_u32 s7, s6, 16384
    v_lshrrev_b32 v13, 3, v1
    v_lshl_add_u32 v220, v13, 11, v220
    v_add_u32 v221, s7, v220
    s_add_u32 s7, s6, 65536
    v_add_u32 v220, s7, v220
    s_nop 2
L_poll_15:
    buffer_load_dwordx4 v[88:91], v221, s[44:47], 0 offen offset:0 sc1
    s_add_u32 s57, s57, 1
    s_cmp_gt_u32 s57, 200000
    s_cbranch_scc1 L_end
    s_waitcnt vmcnt(0)
    v_perm_b32 v13, v89, v88, s54
    v_perm_b32 v14, v91, v90, s55
    v_bitop3_b32 v15, v13, v14, v4 bitop3:0x56
    v_cmp_ne_u32 vcc, 0, v15
    s_mov_b64 exec, vcc
    s_cbranch_vccnz L_poll_15
    s_mov_b64 exec, -1
    v_permlane16_swap_b32 v88, v89
    v_permlane16_swap_b32 v90, v91
    v_add_f32 v88, v88, v89
    v_add_f32 v90, v90, v91
    s_nop 1
    v_permlane32_swap_b32 v88, v90
    v_add_f32 v88, v88, v90
    s_nop 1
    v_add_f32_dpp v88, v88, v88 row_ror:8 row_mask:0xf bank_mask:0xf
    v_cvt_pk_bf16_f32 v88, v88, v88
    v_and_b32 v88, 0xffff0000, v88
    v_mul_f32 v88, v88, v48
    v_cvt_pk_bf16_f32 v88, v88, v88
    v_and_b32 v88, 0xffff0000, v88
    v_add_f32 v212, v212, v88
    v_cvt_pk_bf16_f32 v212, v212, v212
    v_and_b32 v212, 0xffff0000, v212
    v_add_u32 v152, 16384, v220
    v_add_u32 v153, 32768, v220
    v_add_u32 v154, 49152, v220
    v_add_u32 v155, 65536, v220
    v_add_u32 v156, 81920, v220
    v_add_u32 v157, 98304, v220
    s_nop 2
    buffer_load_dwordx4 v[88:91], v220, s[44:47], 0 offen offset:0 sc1
    buffer_load_dwordx4 v[92:95], v152, s[44:47], 0 offen offset:0 sc1
    buffer_load_dwordx4 v[96:99], v153, s[44:47], 0 offen offset:0 sc1
    buffer_load_dwordx4 v[100:103], v154, s[44:47], 0 offen offset:0 sc1
    buffer_load_dwordx4 v[104:107], v155, s[44:47], 0 offen offset:0 sc1
    buffer_load_dwordx4 v[108:111], v156, s[44:47], 0 offen offset:0 sc1
    buffer_load_dwordx4 v[112:115], v157, s[44:47], 0 offen offset:0 sc1
L_poll_16:
    buffer_load_dwordx4 v[88:91], v220, s[44:47], 0 offen offset:0 sc1
    buffer_load_dwordx4 v[92:95], v152, s[44:47], 0 offen offset:0 sc1
    buffer_load_dwordx4 v[96:99], v153, s[44:47], 0 offen offset:0 sc1
    buffer_load_dwordx4 v[100:103], v154, s[44:47], 0 offen offset:0 sc1
    buffer_load_dwordx4 v[104:107], v155, s[44:47], 0 offen offset:0 sc1
    buffer_load_dwordx4 v[108:111], v156, s[44:47], 0 offen offset:0 sc1
    buffer_load_dwordx4 v[112:115], v157, s[44:47], 0 offen offset:0 sc1
    s_add_u32 s57, s57, 1
    s_cmp_gt_u32 s57, 200000
    s_cbranch_scc1 L_end
    s_waitcnt vmcnt(13)
    v_perm_b32 v13, v89, v88, s54
    v_perm_b32 v14, v91, v90, s55
    v_bitop3_b32 v15, v13, v14, v4 bitop3:0x56
    s_waitcnt vmcnt(12)
    v_perm_b32 v13, v93, v92, s54
    v_perm_b32 v14, v95, v94, s55
    v_bitop3_b32 v13, v13, v14, v4 bitop3:0x56
    v_or_b32 v15, v15, v13
    s_waitcnt vmcnt(11)
    v_perm_b32 v13, v97, v96, s54
    v_perm_b32 v14, v99, v98, s55
    v_bitop3_b32 v13, v13, v14, v4 bitop3:0x56
    v_or_b32 v15, v15, v13
    s_waitcnt vmcnt(10)
    v_perm_b32 v13, v101, v100, s54
    v_perm_b32 v14, v103, v102, s55
    v_bitop3_b32 v13, v13, v14, v4 bitop3:0x56
    v_or_b32 v15, v15, v13
    s_waitcnt vmcnt(9)
    v_perm_b32 v13, v105, v104, s54
    v_perm_b32 v14, v107, v106, s55
    v_bitop3_b32 v13, v13, v14, v4 bitop3:0x56
    v_or_b32 v15, v15, v13
    s_waitcnt vmcnt(8)
    v_perm_b32 v13, v109, v108, s54
    v_perm_b32 v14, v111, v110, s55
    v_bitop3_b32 v13, v13, v14, v4 bitop3:0x56
    v_or_b32 v15, v15, v13
    s_waitcnt vmcnt(7)
    v_perm_b32 v13, v113, v112, s54
    v_perm_b32 v14, v115, v114, s55
    v_bitop3_b32 v13, v13, v14, v4 bitop3:0x56
    v_or_b32 v15, v15, v13
    v_cmp_ne_u32 vcc, 0, v15
    s_mov_b64 exec, vcc
    s_cbranch_vccnz L_poll_16
    s_mov_b64 exec, -1
    v_pk_add_f32 v[188:189], v[88:89], v[92:93]
    v_pk_add_f32 v[190:191], v[90:91], v[94:95]
    v_pk_add_f32 v[188:189], v[188:189], v[96:97]
    v_pk_add_f32 v[190:191], v[190:191], v[98:99]
    v_pk_add_f32 v[188:189], v[188:189], v[100:101]
    v_pk_add_f32 v[190:191], v[190:191], v[102:103]
    v_pk_add_f32 v[188:189], v[188:189], v[104:105]
    v_pk_add_f32 v[190:191], v[190:191], v[106:107]
    v_pk_add_f32 v[188:189], v[188:189], v[108:109]
    v_pk_add_f32 v[190:191], v[190:191], v[110:111]
    v_pk_add_f32 v[188:189], v[188:189], v[112:113]
    v_pk_add_f32 v[190:191], v[190:191], v[114:115]
    s_nop 0
    v_permlane16_swap_b32 v188, v189
    v_permlane16_swap_b32 v190, v191
    v_add_f32 v188, v188, v189
    v_add_f32 v190, v190, v191
    s_nop 1
    v_permlane32_swap_b32 v188, v190
    v_add_f32 v188, v188, v190
    s_nop 1
    v_add_f32_dpp v188, v188, v188 row_ror:8 row_mask:0xf bank_mask:0xf
    v_cvt_pk_bf16_f32 v188, v188, v188
    v_and_b32 v188, 0xffff0000, v188
    v_mul_f32 v188, v188, v52
    v_cvt_pk_bf16_f32 v188, v188, v188
    v_and_b32 v188, 0xffff0000, v188
    v_add_f32 v212, v212, v188
    v_cvt_pk_bf16_f32 v212, v212, v212
    s_mov_b32 exec_lo, 0x00ff00ff
    s_mov_b32 exec_hi, 0x00ff00ff
    global_store_short v11, v212, s[38:39]
    s_mov_b64 exec, -1
    s_cmp_lg_u32 s9, 0
    s_cbranch_scc1 L_end
    s_mov_b64 exec, 1
    buffer_store_dword v4, v6, s[44:47], 0 offen offset:0 sc1
    s_endpgm
L_end:
L_end0:
    s_endpgm
L_code_end:
.fill 256, 4, 0xbf810000
.section .rodata,"a"
.p2align 6
.amdhsa_kernel adaLN_cond__sliding_block_cached__glu_gated_geglu__decode_kernel
  .amdhsa_next_free_vgpr 248
  .amdhsa_next_free_sgpr 96
  .amdhsa_accum_offset 248
  .amdhsa_group_segment_fixed_size 0
  .amdhsa_kernarg_size 112
  .amdhsa_user_sgpr_count 2
  .amdhsa_user_sgpr_kernarg_segment_ptr 1
  .amdhsa_system_sgpr_workgroup_id_x 1
  .amdhsa_float_denorm_mode_32 3
.end_amdhsa_kernel
```
